```python
import torch

def _softmax(x, axis=-1):
    return torch.softmax(x, dim=axis)
def _gelu(x):
    return torch.nn.functional.gelu(x, approximate="tanh")
def _silu(x):
    return torch.nn.functional.silu(x)
def _sigmoid(x):
    return torch.sigmoid(x)
def _layernorm(x, axis=-1, eps=1e-5):
    m = x.mean(dim=axis, keepdim=True)
    v = x.var(dim=axis, keepdim=True, unbiased=False)
    return (x - m) / torch.sqrt(v + eps)
def _scatter_add(tgt, idx, src, axis=0):
    return tgt.clone().index_add_(axis, idx, src)
def _segment_sum(src, seg, n):
    out = torch.zeros((n,) + src.shape[1:], dtype=src.dtype)
    return out.index_add_(0, seg, src)
def _pad(x, pw):
    flat = tuple(v for pair in reversed(pw) for v in pair)
    return torch.nn.functional.pad(x, flat)

kernel_name = 'gated_mix__mha_block__mixer_s_mlp__prompt'

def setup_inputs():

    _w = (lambda a: (lambda t: t.to(torch.bfloat16) if t.is_floating_point() else t)(torch.as_tensor(a)))
    def _A_setup():
        B, S, D, H = 1, 2048, 448, 16
        return {
            "x": _w((lambda *s: torch.randn(*s, dtype=torch.bfloat16) * 0.1)(B, S, D)),
            "wqkv": _w((lambda *s: torch.randn(*s, dtype=torch.bfloat16) * 0.8)(D, 3 * D)),
            "wo": _w((lambda *s: torch.randn(*s, dtype=torch.bfloat16) * 0.4)(D, D)),
        }
    _A_in = _A_setup()

    def _B_setup():
        B, S, D, F = 1, 2048, 448, 1792
        return {
            "x":  _w((lambda *s: torch.randn(*s, dtype=torch.bfloat16) * 0.1)(B, S, D)),
            "w1": _w((lambda *s: torch.randn(*s, dtype=torch.bfloat16) * 3.2)(D, D) * (D ** -0.5)),
            "w2": _w((lambda *s: torch.randn(*s, dtype=torch.bfloat16) * 3.2)(D, D) * (D ** -0.5)),
            "w3": _w((lambda *s: torch.randn(*s, dtype=torch.bfloat16) * 3.2)(D, F) * (D ** -0.5)),
            "w4": _w((lambda *s: torch.randn(*s, dtype=torch.bfloat16) * 3.2)(F, D) * (F ** -0.5)),
        }
    _B_in = _B_setup()

    return {
        "A_x": _A_in["x"],
        "A_wqkv": _A_in["wqkv"],
        "A_wo": _A_in["wo"],
        "B_x": _B_in["x"],
        "B_w1": _B_in["w1"],
        "B_w2": _B_in["w2"],
        "B_w3": _B_in["w3"],
        "B_w4": _B_in["w4"],
        "gate_w": _w((lambda *s: torch.randn(*s, dtype=torch.bfloat16) * 0.1)(448) * 16.0),
    }

def reference(A_x, A_wqkv, A_wo, B_x, B_w1, B_w2, B_w3, B_w4, gate_w):
    def _A_ref(x, wqkv, wo):
        B, S, D = x.shape
        H = 16
        Dh = D // H
        qkv = (lambda x, *d: x.permute(*d))((x @ wqkv).reshape(B, S, 3, H, Dh), 2, 0, 3, 1, 4)
        q, k, v = qkv[0], qkv[1], qkv[2]
        scores = torch.einsum("bhqd,bhkd->bhqk", q, k) * (Dh ** -0.5)
        p = _softmax(scores, axis=-1)
        o = torch.einsum("bhqk,bhkd->bhqd", p, v)
        return (lambda x, *d: x.permute(*d))(o, 0, 2, 1, 3).reshape(B, S, D) @ wo

    def _B_ref(x, w1, w2, w3, w4):
        B, S, D = x.shape
        h = _gelu(_layernorm(x, axis=-1) @ w1)
        c = D // 4
        g0 = _pad(h[:, :, 0*c:1*c], ((0, 0), (1, 0), (0, 0)))[:, :S, :]
        g1 = _pad(h[:, :, 1*c:2*c], ((0, 0), (0, 1), (0, 0)))[:, 1:, :]
        g2 = _pad(h[:, :, 2*c:3*c], ((0, 0), (2, 0), (0, 0)))[:, :S, :]
        g3 = _pad(h[:, :, 3*c:   ], ((0, 0), (0, 2), (0, 0)))[:, 2:, :]
        hs = torch.concatenate([g0, g1, g2, g3], axis=-1) @ w2
        x1 = x + hs
        h2 = _gelu(_layernorm(x1, axis=-1) @ w3) @ w4
        return x1 + h2

    x = A_x
    g = _sigmoid((x * gate_w).sum(-1, keepdims=True))
    a = _A_ref(x, A_wqkv, A_wo)
    b = _B_ref(x, B_w1, B_w2, B_w3, B_w4)
    return g * a + (1 - g) * b
```

```asm
; @launch kernel=k1_kernel grid=(256,1,1) block=(512,1,1) lds=131072
; @launch kernel=km_kernel grid=(480,1,1) block=(512,1,1) lds=81920
.amdgcn_target "amdgcn-amd-amdhsa--gfx950"
.text
.globl k1_kernel
.p2align 8
.type k1_kernel,@function
k1_kernel:
    s_cmp_ge_u32 s2, 256
    s_cbranch_scc1 K1_END
    s_load_dwordx4 s[4:7], s[0:1], 0
    s_load_dwordx2 s[8:9], s[0:1], 32
    s_load_dwordx2 s[10:11], s[0:1], 88
    s_load_dwordx4 s[36:39], s[0:1], 40
    s_load_dwordx4 s[40:43], s[0:1], 56
    s_load_dwordx2 s[66:67], s[0:1], 16
    v_and_b32 v1, 63, v0
    v_lshrrev_b32 v2, 6, v0
    s_nop 0
    v_readfirstlane_b32 s26, v2
    s_and_b32 s24, s2, 15
    s_lshr_b32 s25, s2, 4
    s_add_u32 s25, s25, 12
    s_and_b32 s25, s25, 15
    s_lshl_b32 s34, s2, 3
    s_add_u32 s34, s34, s26
    s_lshl_b32 s32, s26, 11
    s_and_b32 s52, s26, 1
    s_lshr_b32 s53, s26, 1
    s_mov_b32 s60, 0
    s_mov_b32 s61, -1
    s_cmp_ge_u32 s25, 12
    s_mov_b32 s27, 2688
    s_cselect_b32 s27, 896, s27
    s_cselect_b32 s29, 64, 56
    s_mul_i32 s28, s25, 224
    s_sub_u32 s35, s25, 12
    s_lshl_b32 s35, s35, 8
    s_cmp_ge_u32 s25, 12
    s_cselect_b32 s28, s35, s28
    s_lshl_b32 s33, s27, 6
    v_lshrrev_b32 v20, 2, v1
    v_and_b32 v21, 3, v1
    v_bfe_u32 v22, v1, 4, 2
    v_xor_b32 v21, v21, v22
    s_lshl_b32 s35, s24, 7
    s_lshl_b32 s48, s26, 4
    s_add_u32 s35, s35, s48
    v_add_u32 v20, s35, v20
    v_mul_u32_u24 v20, 896, v20
    v_lshl_add_u32 v2, v21, 4, v20
    v_add_u32 v3, 64, v2
    v_lshrrev_b32 v20, 4, v1
    v_lshlrev_b32 v21, 2, v20
    v_sub_u32 v21, v1, v21
    v_and_b32 v21, 15, v21
    s_lshl_b32 s35, s26, 3
    v_add_u32 v20, s35, v20
    v_mul_lo_u32 v20, v20, s27
    v_lshl_add_u32 v20, v21, 4, v20
    v_add_u32 v6, s28, v20
    s_lshl_b32 s35, s27, 2
    v_add_u32 v7, s35, v6
    s_waitcnt lgkmcnt(0)
    s_mov_b32 s12, s4
    s_and_b32 s13, s5, 0xffff
    s_mov_b32 s14, 1835008
    s_mov_b32 s15, 0x00020000
    s_mov_b32 s20, s10
    s_and_b32 s21, s11, 0xffff
    s_mov_b32 s22, 268435456
    s_mov_b32 s23, 0x00020000
    s_cmp_ge_u32 s25, 12
    s_cselect_b32 s16, s8, s6
    s_cselect_b32 s17, s9, s7
    s_mov_b32 s18, 1204224
    s_cselect_b32 s18, 401408, s18
    s_and_b32 s17, s17, 0xffff
    s_mov_b32 s19, 0x00020000
    s_mov_b32 s54, 0
    s_cmp_lg_u32 s25, 15
    s_cbranch_scc1 K1_NOGW
    s_cmp_lg_u32 s53, 2
    s_cbranch_scc1 K1_NOGW
    s_mov_b32 s54, 1
    s_mov_b32 s44, s42
    s_and_b32 s45, s43, 0xffff
    s_mov_b32 s46, 896
    s_mov_b32 s47, 0x00020000
    v_lshrrev_b32 v20, 5, v1
    v_lshlrev_b32 v20, 4, v20
    buffer_load_dwordx4 v[128:131], v20, s[44:47], 0 offen offset:0
    buffer_load_dwordx4 v[132:135], v20, s[44:47], 0 offen offset:32
    buffer_load_dwordx4 v[136:139], v20, s[44:47], 0 offen offset:64
    buffer_load_dwordx4 v[140:143], v20, s[44:47], 0 offen offset:96
    buffer_load_dwordx4 v[144:147], v20, s[44:47], 0 offen offset:128
    buffer_load_dwordx4 v[148:151], v20, s[44:47], 0 offen offset:160
    buffer_load_dwordx4 v[152:155], v20, s[44:47], 0 offen offset:192
    buffer_load_dwordx4 v[156:159], v20, s[44:47], 0 offen offset:224
    buffer_load_dwordx4 v[160:163], v20, s[44:47], 0 offen offset:256
    buffer_load_dwordx4 v[164:167], v20, s[44:47], 0 offen offset:288
    buffer_load_dwordx4 v[168:171], v20, s[44:47], 0 offen offset:320
    buffer_load_dwordx4 v[172:175], v20, s[44:47], 0 offen offset:352
    buffer_load_dwordx4 v[176:179], v20, s[44:47], 0 offen offset:384
    buffer_load_dwordx4 v[180:183], v20, s[44:47], 0 offen offset:416
    buffer_load_dwordx4 v[184:187], v20, s[44:47], 0 offen offset:448
    buffer_load_dwordx4 v[188:191], v20, s[44:47], 0 offen offset:480
    buffer_load_dwordx4 v[192:195], v20, s[44:47], 0 offen offset:512
    buffer_load_dwordx4 v[196:199], v20, s[44:47], 0 offen offset:544
    buffer_load_dwordx4 v[200:203], v20, s[44:47], 0 offen offset:576
    buffer_load_dwordx4 v[204:207], v20, s[44:47], 0 offen offset:608
    buffer_load_dwordx4 v[208:211], v20, s[44:47], 0 offen offset:640
    buffer_load_dwordx4 v[212:215], v20, s[44:47], 0 offen offset:672
    buffer_load_dwordx4 v[216:219], v20, s[44:47], 0 offen offset:704
    buffer_load_dwordx4 v[220:223], v20, s[44:47], 0 offen offset:736
    buffer_load_dwordx4 v[224:227], v20, s[44:47], 0 offen offset:768
    buffer_load_dwordx4 v[228:231], v20, s[44:47], 0 offen offset:800
    buffer_load_dwordx4 v[232:235], v20, s[44:47], 0 offen offset:832
    buffer_load_dwordx4 v[236:239], v20, s[44:47], 0 offen offset:864
K1_NOGW:
    s_mov_b32 s30, 0
    s_mul_i32 s31, s33, 0
    s_add_u32 m0, s32, 0
    s_nop 0
    buffer_load_dwordx4 v2, s[12:15], s30 offen lds
    s_add_u32 m0, s32, 1024
    s_nop 0
    buffer_load_dwordx4 v3, s[12:15], s30 offen lds
    s_add_u32 m0, s32, 16384
    s_nop 0
    buffer_load_dwordx4 v6, s[16:19], s31 offen lds
    s_add_u32 m0, s32, 17408
    s_nop 0
    buffer_load_dwordx4 v7, s[16:19], s31 offen lds
    s_mov_b32 s30, 128
    s_mul_i32 s31, s33, 1
    s_add_u32 m0, s32, 32768
    s_nop 0
    buffer_load_dwordx4 v2, s[12:15], s30 offen lds
    s_add_u32 m0, s32, 33792
    s_nop 0
    buffer_load_dwordx4 v3, s[12:15], s30 offen lds
    s_add_u32 m0, s32, 49152
    s_nop 0
    buffer_load_dwordx4 v6, s[16:19], s31 offen lds
    s_add_u32 m0, s32, 50176
    s_nop 0
    buffer_load_dwordx4 v7, s[16:19], s31 offen lds
    s_mov_b32 s30, 256
    s_mul_i32 s31, s33, 2
    s_add_u32 m0, s32, 65536
    s_nop 0
    buffer_load_dwordx4 v2, s[12:15], s30 offen lds
    s_add_u32 m0, s32, 66560
    s_nop 0
    buffer_load_dwordx4 v3, s[12:15], s30 offen lds
    s_add_u32 m0, s32, 81920
    s_nop 0
    buffer_load_dwordx4 v6, s[16:19], s31 offen lds
    s_add_u32 m0, s32, 82944
    s_nop 0
    buffer_load_dwordx4 v7, s[16:19], s31 offen lds
    v_and_b32 v26, 31, v1
    v_lshlrev_b32 v26, 1, v26
    v_lshrrev_b32 v27, 5, v1
    v_lshlrev_b32 v27, 2, v27
    s_mov_b32 s47, 0x00020000
    s_sub_u32 s35, s34, 1568
    s_cmp_lt_u32 s34, 1568
    s_cselect_b32 s48, s34, s35
    s_cselect_b32 s44, s38, s36
    s_cselect_b32 s45, s39, s37
    s_mov_b32 s46, 401408
    s_cselect_b32 s46, 1605632, s46
    s_mov_b32 s49, 896
    s_cselect_b32 s49, 3584, s49
    s_mov_b32 s50, 23068672
    s_cselect_b32 s50, 24117248, s50
    s_mul_hi_u32 s62, s48, 153391690
    s_mul_i32 s63, s62, 28
    s_sub_u32 s63, s48, s63
    s_lshl_b32 s58, s63, 4
    s_mov_b32 s59, 0
    s_cmp_ge_u32 s34, 1960
    s_cselect_b32 s46, 0, s46
    s_cselect_b32 s55, 1, 0
    s_and_b32 s45, s45, 0xffff
    s_lshl_b32 s35, s48, 10
    s_add_u32 s56, s50, s35
    s_cmp_lg_u32 s55, 0
    s_cselect_b32 s56, -1, s56
    s_mul_i32 s58, s58, s49
    s_lshl_b32 s62, s62, 6
    s_add_u32 s58, s58, s62
    v_mul_lo_u32 v28, v27, s49
    v_add_u32 v28, v28, v26
    v_lshrrev_b32 v29, 2, v27
    v_mul_lo_u32 v29, v29, s59
    v_add_u32 v29, v29, v28
    buffer_load_ushort v240, v28, s[44:47], s58 offen
    s_mul_i32 s35, s49, 1
    s_add_u32 s35, s35, s58
    buffer_load_ushort v241, v28, s[44:47], s35 offen
    s_mul_i32 s35, s49, 2
    s_add_u32 s35, s35, s58
    buffer_load_ushort v242, v28, s[44:47], s35 offen
    s_mul_i32 s35, s49, 3
    s_add_u32 s35, s35, s58
    buffer_load_ushort v243, v28, s[44:47], s35 offen
    s_mul_i32 s35, s49, 8
    s_add_u32 s35, s35, s58
    buffer_load_ushort v244, v29, s[44:47], s35 offen
    s_mul_i32 s35, s49, 9
    s_add_u32 s35, s35, s58
    buffer_load_ushort v245, v29, s[44:47], s35 offen
    s_mul_i32 s35, s49, 10
    s_add_u32 s35, s35, s58
    buffer_load_ushort v246, v29, s[44:47], s35 offen
    s_mul_i32 s35, s49, 11
    s_add_u32 s35, s35, s58
    buffer_load_ushort v247, v29, s[44:47], s35 offen
    s_mul_hi_u32 s62, s34, 38347923
    s_mul_i32 s63, s62, 112
    s_sub_u32 s63, s34, s63
    s_lshl_b32 s58, s63, 4
    s_sub_u32 s35, s34, 1568
    s_lshr_b32 s55, s35, 5
    s_and_b32 s63, s35, 31
    s_lshr_b32 s64, s63, 1
    s_mul_i32 s64, s64, 28
    s_and_b32 s63, s63, 1
    s_lshl_b32 s65, s63, 4
    s_add_u32 s64, s64, s65
    s_lshl_b32 s63, s63, 30
    s_cmp_lt_u32 s34, 1568
    s_cselect_b32 s48, s34, s35
    s_cselect_b32 s44, s40, s66
    s_cselect_b32 s45, s41, s67
    s_mov_b32 s46, 401408
    s_cselect_b32 s46, 1605632, s46
    s_mov_b32 s49, 896
    s_mov_b32 s50, 28311552
    s_cselect_b32 s50, 26214400, s50
    s_cselect_b32 s62, s62, s55
    s_cselect_b32 s58, s58, s64
    s_cselect_b32 s59, 0, s63
    s_cmp_ge_u32 s34, 2016
    s_cselect_b32 s46, 0, s46
    s_cselect_b32 s55, 1, 0
    s_and_b32 s45, s45, 0xffff
    s_lshl_b32 s35, s48, 10
    s_add_u32 s57, s50, s35
    s_cmp_lg_u32 s55, 0
    s_cselect_b32 s57, -1, s57
    s_mul_i32 s58, s58, s49
    s_lshl_b32 s62, s62, 6
    s_add_u32 s58, s58, s62
    v_mul_lo_u32 v28, v27, s49
    v_add_u32 v28, v28, v26
    v_lshrrev_b32 v29, 2, v27
    v_mul_lo_u32 v29, v29, s59
    v_add_u32 v29, v29, v28
    buffer_load_ushort v248, v28, s[44:47], s58 offen
    s_mul_i32 s35, s49, 1
    s_add_u32 s35, s35, s58
    buffer_load_ushort v249, v28, s[44:47], s35 offen
    s_mul_i32 s35, s49, 2
    s_add_u32 s35, s35, s58
    buffer_load_ushort v250, v28, s[44:47], s35 offen
    s_mul_i32 s35, s49, 3
    s_add_u32 s35, s35, s58
    buffer_load_ushort v251, v28, s[44:47], s35 offen
    s_mul_i32 s35, s49, 8
    s_add_u32 s35, s35, s58
    buffer_load_ushort v252, v29, s[44:47], s35 offen
    s_mul_i32 s35, s49, 9
    s_add_u32 s35, s35, s58
    buffer_load_ushort v253, v29, s[44:47], s35 offen
    s_mul_i32 s35, s49, 10
    s_add_u32 s35, s35, s58
    buffer_load_ushort v254, v29, s[44:47], s35 offen
    s_mul_i32 s35, s49, 11
    s_add_u32 s35, s35, s58
    buffer_load_ushort v255, v29, s[44:47], s35 offen
    v_lshrrev_b32 v20, 5, v1
    v_bfe_u32 v21, v1, 2, 2
    v_bfe_u32 v22, v1, 4, 1
    s_lshl_b32 s35, s52, 2
    v_add_u32 v22, s35, v22
    v_lshlrev_b32 v22, 11, v22
    v_and_b32 v23, 15, v1
    v_lshl_add_u32 v22, v23, 6, v22
    v_xor_b32 v23, v20, v21
    v_lshl_add_u32 v10, v23, 4, v22
    v_xor_b32 v23, 2, v23
    v_lshl_add_u32 v11, v23, 4, v22
    v_add_u32 v12, 0x10000, v10
    v_add_u32 v13, 0x10000, v11
    v_lshl_add_u32 v22, v20, 3, v21
    v_lshlrev_b32 v22, 8, v22
    v_bfe_u32 v23, v1, 4, 1
    v_lshlrev_b32 v23, 5, v23
    v_and_b32 v24, 3, v1
    v_lshl_add_u32 v23, v24, 3, v23
    v_lshl_add_u32 v23, v21, 6, v23
    s_mul_i32 s35, s53, s29
    v_add_u32 v24, s35, v23
    v_and_b32 v24, 255, v24
    v_add_u32 v14, v22, v24
    v_add_u32 v15, 0x10000, v14
    v_mov_b32 v18, 0x3f803f80
    v_mov_b32 v20, 0
    v_mov_b32 v21, 0
    v_mov_b32 v22, 0
    v_mov_b32 v23, 0
    v_mov_b32 v24, 0
    v_mov_b32 v25, 0
    v_mov_b32 v26, 0
    s_waitcnt vmcnt(24)
    s_barrier
    ds_read_b128 v[32:35], v10 offset:0
    ds_read_b128 v[36:39], v10 offset:4096
    ds_read_b64_tr_b16 v[40:41], v14 offset:16384
    ds_read_b64_tr_b16 v[42:43], v14 offset:17408
    s_cmp_ge_u32 s25, 12
    s_cbranch_scc1 K1_LOOP_H
    s_cmp_ge_u32 s25, 8
    s_cbranch_scc1 K1_LOOP_V
    s_setprio 2
    ds_read_b128 v[44:47], v11 offset:0
    ds_read_b128 v[48:51], v11 offset:4096
    ds_read_b64_tr_b16 v[52:53], v14 offset:20480
    ds_read_b64_tr_b16 v[54:55], v14 offset:21504
    s_waitcnt lgkmcnt(4)
    v_mfma_f32_32x32x16_bf16 v[64:79], v[40:43], v[32:35], 0
    v_mfma_f32_32x32x16_bf16 v[80:95], v[40:43], v[36:39], 0
    s_setprio 1
    ds_read_b128 v[32:35], v10 offset:1024
    ds_read_b128 v[36:39], v10 offset:5120
    ds_read_b64_tr_b16 v[40:41], v14 offset:24576
    ds_read_b64_tr_b16 v[42:43], v14 offset:25600
    s_waitcnt lgkmcnt(4)
    v_mfma_f32_32x32x16_bf16 v[64:79], v[52:55], v[44:47], v[64:79]
    v_mfma_f32_32x32x16_bf16 v[80:95], v[52:55], v[48:51], v[80:95]
    s_setprio 0
    ds_read_b128 v[44:47], v11 offset:1024
    ds_read_b128 v[48:51], v11 offset:5120
    ds_read_b64_tr_b16 v[52:53], v14 offset:28672
    ds_read_b64_tr_b16 v[54:55], v14 offset:29696
    s_waitcnt lgkmcnt(4)
    v_mfma_f32_32x32x16_bf16 v[64:79], v[40:43], v[32:35], v[64:79]
    v_mfma_f32_32x32x16_bf16 v[80:95], v[40:43], v[36:39], v[80:95]
    s_waitcnt vmcnt(20)
    s_barrier
    s_setprio 3
    s_mov_b32 s30, 384
    s_mul_i32 s31, s33, 3
    s_add_u32 m0, s32, 98304
    s_nop 0
    buffer_load_dwordx4 v2, s[12:15], s30 offen lds
    s_add_u32 m0, s32, 99328
    s_nop 0
    buffer_load_dwordx4 v3, s[12:15], s30 offen lds
    s_add_u32 m0, s32, 114688
    s_nop 0
    buffer_load_dwordx4 v6, s[16:19], s31 offen lds
    s_add_u32 m0, s32, 115712
    s_nop 0
    buffer_load_dwordx4 v7, s[16:19], s31 offen lds
    ds_read_b128 v[32:35], v10 offset:32768
    ds_read_b128 v[36:39], v10 offset:36864
    ds_read_b64_tr_b16 v[40:41], v14 offset:49152
    ds_read_b64_tr_b16 v[42:43], v14 offset:50176
    s_waitcnt lgkmcnt(4)
    v_mfma_f32_32x32x16_bf16 v[64:79], v[52:55], v[44:47], v[64:79]
    v_mfma_f32_32x32x16_bf16 v[80:95], v[52:55], v[48:51], v[80:95]
    s_setprio 2
    ds_read_b128 v[44:47], v11 offset:32768
    ds_read_b128 v[48:51], v11 offset:36864
    ds_read_b64_tr_b16 v[52:53], v14 offset:53248
    ds_read_b64_tr_b16 v[54:55], v14 offset:54272
    s_waitcnt lgkmcnt(4)
    v_mfma_f32_32x32x16_bf16 v[64:79], v[40:43], v[32:35], v[64:79]
    v_mfma_f32_32x32x16_bf16 v[80:95], v[40:43], v[36:39], v[80:95]
    s_setprio 1
    ds_read_b128 v[32:35], v10 offset:33792
    ds_read_b128 v[36:39], v10 offset:37888
    ds_read_b64_tr_b16 v[40:41], v14 offset:57344
    ds_read_b64_tr_b16 v[42:43], v14 offset:58368
    s_waitcnt lgkmcnt(4)
    v_mfma_f32_32x32x16_bf16 v[64:79], v[52:55], v[44:47], v[64:79]
    v_mfma_f32_32x32x16_bf16 v[80:95], v[52:55], v[48:51], v[80:95]
    s_setprio 0
    ds_read_b128 v[44:47], v11 offset:33792
    ds_read_b128 v[48:51], v11 offset:37888
    ds_read_b64_tr_b16 v[52:53], v14 offset:61440
    ds_read_b64_tr_b16 v[54:55], v14 offset:62464
    s_waitcnt lgkmcnt(4)
    v_mfma_f32_32x32x16_bf16 v[64:79], v[40:43], v[32:35], v[64:79]
    v_mfma_f32_32x32x16_bf16 v[80:95], v[40:43], v[36:39], v[80:95]
    s_waitcnt vmcnt(20)
    s_barrier
    s_setprio 3
    s_mov_b32 s30, 512
    s_mul_i32 s31, s33, 4
    s_add_u32 m0, s32, 0
    s_nop 0
    buffer_load_dwordx4 v2, s[12:15], s30 offen lds
    s_add_u32 m0, s32, 1024
    s_nop 0
    buffer_load_dwordx4 v3, s[12:15], s30 offen lds
    s_add_u32 m0, s32, 16384
    s_nop 0
    buffer_load_dwordx4 v6, s[16:19], s31 offen lds
    s_add_u32 m0, s32, 17408
    s_nop 0
    buffer_load_dwordx4 v7, s[16:19], s31 offen lds
    ds_read_b128 v[32:35], v12 offset:0
    ds_read_b128 v[36:39], v12 offset:4096
    ds_read_b64_tr_b16 v[40:41], v15 offset:16384
    ds_read_b64_tr_b16 v[42:43], v15 offset:17408
    s_waitcnt lgkmcnt(4)
    v_mfma_f32_32x32x16_bf16 v[64:79], v[52:55], v[44:47], v[64:79]
    v_mfma_f32_32x32x16_bf16 v[80:95], v[52:55], v[48:51], v[80:95]
    s_setprio 2
    ds_read_b128 v[44:47], v13 offset:0
    ds_read_b128 v[48:51], v13 offset:4096
    ds_read_b64_tr_b16 v[52:53], v15 offset:20480
    ds_read_b64_tr_b16 v[54:55], v15 offset:21504
    s_waitcnt lgkmcnt(4)
    v_mfma_f32_32x32x16_bf16 v[64:79], v[40:43], v[32:35], v[64:79]
    v_mfma_f32_32x32x16_bf16 v[80:95], v[40:43], v[36:39], v[80:95]
    s_setprio 1
    ds_read_b128 v[32:35], v12 offset:1024
    ds_read_b128 v[36:39], v12 offset:5120
    ds_read_b64_tr_b16 v[40:41], v15 offset:24576
    ds_read_b64_tr_b16 v[42:43], v15 offset:25600
    s_waitcnt lgkmcnt(4)
    v_mfma_f32_32x32x16_bf16 v[64:79], v[52:55], v[44:47], v[64:79]
    v_mfma_f32_32x32x16_bf16 v[80:95], v[52:55], v[48:51], v[80:95]
    s_setprio 0
    ds_read_b128 v[44:47], v13 offset:1024
    ds_read_b128 v[48:51], v13 offset:5120
    ds_read_b64_tr_b16 v[52:53], v15 offset:28672
    ds_read_b64_tr_b16 v[54:55], v15 offset:29696
    s_waitcnt lgkmcnt(4)
    v_mfma_f32_32x32x16_bf16 v[64:79], v[40:43], v[32:35], v[64:79]
    v_mfma_f32_32x32x16_bf16 v[80:95], v[40:43], v[36:39], v[80:95]
    s_waitcnt vmcnt(4)
    s_barrier
    s_setprio 3
    s_mov_b32 s30, 640
    s_mul_i32 s31, s33, 5
    s_add_u32 m0, s32, 32768
    s_nop 0
    buffer_load_dwordx4 v2, s[12:15], s30 offen lds
    s_add_u32 m0, s32, 33792
    s_nop 0
    buffer_load_dwordx4 v3, s[12:15], s30 offen lds
    s_add_u32 m0, s32, 49152
    s_nop 0
    buffer_load_dwordx4 v6, s[16:19], s31 offen lds
    s_add_u32 m0, s32, 50176
    s_nop 0
    buffer_load_dwordx4 v7, s[16:19], s31 offen lds
    ds_read_b128 v[32:35], v12 offset:32768
    ds_read_b128 v[36:39], v12 offset:36864
    ds_read_b64_tr_b16 v[40:41], v15 offset:49152
    ds_read_b64_tr_b16 v[42:43], v15 offset:50176
    s_waitcnt lgkmcnt(4)
    v_mfma_f32_32x32x16_bf16 v[64:79], v[52:55], v[44:47], v[64:79]
    v_mfma_f32_32x32x16_bf16 v[80:95], v[52:55], v[48:51], v[80:95]
    s_setprio 2
    ds_read_b128 v[44:47], v13 offset:32768
    ds_read_b128 v[48:51], v13 offset:36864
    ds_read_b64_tr_b16 v[52:53], v15 offset:53248
    ds_read_b64_tr_b16 v[54:55], v15 offset:54272
    s_waitcnt lgkmcnt(4)
    v_mfma_f32_32x32x16_bf16 v[64:79], v[40:43], v[32:35], v[64:79]
    v_mfma_f32_32x32x16_bf16 v[80:95], v[40:43], v[36:39], v[80:95]
    s_setprio 1
    ds_read_b128 v[32:35], v12 offset:33792
    ds_read_b128 v[36:39], v12 offset:37888
    ds_read_b64_tr_b16 v[40:41], v15 offset:57344
    ds_read_b64_tr_b16 v[42:43], v15 offset:58368
    s_waitcnt lgkmcnt(4)
    v_mfma_f32_32x32x16_bf16 v[64:79], v[52:55], v[44:47], v[64:79]
    v_mfma_f32_32x32x16_bf16 v[80:95], v[52:55], v[48:51], v[80:95]
    s_setprio 0
    ds_read_b128 v[44:47], v13 offset:33792
    ds_read_b128 v[48:51], v13 offset:37888
    ds_read_b64_tr_b16 v[52:53], v15 offset:61440
    ds_read_b64_tr_b16 v[54:55], v15 offset:62464
    s_waitcnt lgkmcnt(4)
    v_mfma_f32_32x32x16_bf16 v[64:79], v[40:43], v[32:35], v[64:79]
    v_mfma_f32_32x32x16_bf16 v[80:95], v[40:43], v[36:39], v[80:95]
    s_waitcnt vmcnt(4)
    s_barrier
    s_setprio 3
    s_mov_b32 s30, 768
    s_mul_i32 s31, s33, 6
    s_add_u32 m0, s32, 65536
    s_nop 0
    buffer_load_dwordx4 v2, s[12:15], s30 offen lds
    s_add_u32 m0, s32, 66560
    s_nop 0
    buffer_load_dwordx4 v3, s[12:15], s30 offen lds
    s_add_u32 m0, s32, 81920
    s_nop 0
    buffer_load_dwordx4 v6, s[16:19], s31 offen lds
    s_add_u32 m0, s32, 82944
    s_nop 0
    buffer_load_dwordx4 v7, s[16:19], s31 offen lds
    ds_read_b128 v[32:35], v10 offset:0
    ds_read_b128 v[36:39], v10 offset:4096
    ds_read_b64_tr_b16 v[40:41], v14 offset:16384
    ds_read_b64_tr_b16 v[42:43], v14 offset:17408
    s_waitcnt lgkmcnt(4)
    v_mfma_f32_32x32x16_bf16 v[64:79], v[52:55], v[44:47], v[64:79]
    v_mfma_f32_32x32x16_bf16 v[80:95], v[52:55], v[48:51], v[80:95]
    s_setprio 2
    ds_read_b128 v[44:47], v11 offset:0
    ds_read_b128 v[48:51], v11 offset:4096
    ds_read_b64_tr_b16 v[52:53], v14 offset:20480
    ds_read_b64_tr_b16 v[54:55], v14 offset:21504
    s_waitcnt lgkmcnt(4)
    v_mfma_f32_32x32x16_bf16 v[64:79], v[40:43], v[32:35], v[64:79]
    v_mfma_f32_32x32x16_bf16 v[80:95], v[40:43], v[36:39], v[80:95]
    s_setprio 1
    ds_read_b128 v[32:35], v10 offset:1024
    ds_read_b128 v[36:39], v10 offset:5120
    ds_read_b64_tr_b16 v[40:41], v14 offset:24576
    ds_read_b64_tr_b16 v[42:43], v14 offset:25600
    s_waitcnt lgkmcnt(4)
    v_mfma_f32_32x32x16_bf16 v[64:79], v[52:55], v[44:47], v[64:79]
    v_mfma_f32_32x32x16_bf16 v[80:95], v[52:55], v[48:51], v[80:95]
    s_setprio 0
    ds_read_b128 v[44:47], v11 offset:1024
    ds_read_b128 v[48:51], v11 offset:5120
    ds_read_b64_tr_b16 v[52:53], v14 offset:28672
    ds_read_b64_tr_b16 v[54:55], v14 offset:29696
    s_waitcnt lgkmcnt(4)
    v_mfma_f32_32x32x16_bf16 v[64:79], v[40:43], v[32:35], v[64:79]
    v_mfma_f32_32x32x16_bf16 v[80:95], v[40:43], v[36:39], v[80:95]
    s_waitcnt vmcnt(4)
    s_barrier
    s_setprio 3
    ds_read_b128 v[32:35], v10 offset:32768
    ds_read_b128 v[36:39], v10 offset:36864
    ds_read_b64_tr_b16 v[40:41], v14 offset:49152
    ds_read_b64_tr_b16 v[42:43], v14 offset:50176
    s_waitcnt lgkmcnt(4)
    v_mfma_f32_32x32x16_bf16 v[64:79], v[52:55], v[44:47], v[64:79]
    v_mfma_f32_32x32x16_bf16 v[80:95], v[52:55], v[48:51], v[80:95]
    s_setprio 2
    ds_read_b128 v[44:47], v11 offset:32768
    ds_read_b128 v[48:51], v11 offset:36864
    ds_read_b64_tr_b16 v[52:53], v14 offset:53248
    ds_read_b64_tr_b16 v[54:55], v14 offset:54272
    s_waitcnt lgkmcnt(4)
    v_mfma_f32_32x32x16_bf16 v[64:79], v[40:43], v[32:35], v[64:79]
    v_mfma_f32_32x32x16_bf16 v[80:95], v[40:43], v[36:39], v[80:95]
    s_setprio 1
    ds_read_b128 v[32:35], v10 offset:33792
    ds_read_b128 v[36:39], v10 offset:37888
    ds_read_b64_tr_b16 v[40:41], v14 offset:57344
    ds_read_b64_tr_b16 v[42:43], v14 offset:58368
    s_waitcnt lgkmcnt(4)
    v_mfma_f32_32x32x16_bf16 v[64:79], v[52:55], v[44:47], v[64:79]
    v_mfma_f32_32x32x16_bf16 v[80:95], v[52:55], v[48:51], v[80:95]
    s_setprio 0
    ds_read_b128 v[44:47], v11 offset:33792
    ds_read_b128 v[48:51], v11 offset:37888
    ds_read_b64_tr_b16 v[52:53], v14 offset:61440
    ds_read_b64_tr_b16 v[54:55], v14 offset:62464
    s_waitcnt lgkmcnt(4)
    v_mfma_f32_32x32x16_bf16 v[64:79], v[40:43], v[32:35], v[64:79]
    v_mfma_f32_32x32x16_bf16 v[80:95], v[40:43], v[36:39], v[80:95]
    s_waitcnt vmcnt(0)
    s_barrier
    s_setprio 3
    ds_read_b128 v[32:35], v12 offset:0
    ds_read_b128 v[36:39], v12 offset:4096
    ds_read_b64_tr_b16 v[40:41], v15 offset:16384
    ds_read_b64_tr_b16 v[42:43], v15 offset:17408
    s_waitcnt lgkmcnt(4)
    v_mfma_f32_32x32x16_bf16 v[64:79], v[52:55], v[44:47], v[64:79]
    v_mfma_f32_32x32x16_bf16 v[80:95], v[52:55], v[48:51], v[80:95]
    s_setprio 2
    ds_read_b128 v[44:47], v13 offset:0
    ds_read_b128 v[48:51], v13 offset:4096
    ds_read_b64_tr_b16 v[52:53], v15 offset:20480
    ds_read_b64_tr_b16 v[54:55], v15 offset:21504
    s_waitcnt lgkmcnt(4)
    v_mfma_f32_32x32x16_bf16 v[64:79], v[40:43], v[32:35], v[64:79]
    v_mfma_f32_32x32x16_bf16 v[80:95], v[40:43], v[36:39], v[80:95]
    s_setprio 1
    ds_read_b128 v[32:35], v12 offset:1024
    ds_read_b128 v[36:39], v12 offset:5120
    ds_read_b64_tr_b16 v[40:41], v15 offset:24576
    ds_read_b64_tr_b16 v[42:43], v15 offset:25600
    s_waitcnt lgkmcnt(4)
    v_mfma_f32_32x32x16_bf16 v[64:79], v[52:55], v[44:47], v[64:79]
    v_mfma_f32_32x32x16_bf16 v[80:95], v[52:55], v[48:51], v[80:95]
    s_setprio 0
    ds_read_b128 v[44:47], v13 offset:1024
    ds_read_b128 v[48:51], v13 offset:5120
    ds_read_b64_tr_b16 v[52:53], v15 offset:28672
    ds_read_b64_tr_b16 v[54:55], v15 offset:29696
    s_waitcnt lgkmcnt(4)
    v_mfma_f32_32x32x16_bf16 v[64:79], v[40:43], v[32:35], v[64:79]
    v_mfma_f32_32x32x16_bf16 v[80:95], v[40:43], v[36:39], v[80:95]
    s_waitcnt lgkmcnt(0)
    v_mfma_f32_32x32x16_bf16 v[64:79], v[52:55], v[44:47], v[64:79]
    v_mfma_f32_32x32x16_bf16 v[80:95], v[52:55], v[48:51], v[80:95]
    s_cmp_ge_u32 s25, 4
    s_cselect_b32 s35, 1.0, 0x3e8b97f6
    s_cselect_b32 s48, 0x3f80, 0
    s_lshl_b32 s49, s25, 19
    s_lshl_b32 s50, s53, 17
    s_add_u32 s49, s49, s50
    s_lshl_b32 s50, s24, 13
    s_add_u32 s49, s49, s50
    s_lshl_b32 s50, s52, 12
    s_add_u32 s49, s49, s50
    v_lshlrev_b32 v2, 4, v1
    v_mov_b32 v3, s48
    s_nop 7
    v_mul_f32 v64, s35, v64
    v_mul_f32 v65, s35, v65
    v_mul_f32 v66, s35, v66
    v_mul_f32 v67, s35, v67
    v_mul_f32 v68, s35, v68
    v_mul_f32 v69, s35, v69
    v_mul_f32 v70, s35, v70
    v_mul_f32 v71, s35, v71
    v_mul_f32 v72, s35, v72
    v_mul_f32 v73, s35, v73
    v_mul_f32 v74, s35, v74
    v_mul_f32 v75, s35, v75
    v_mul_f32 v76, s35, v76
    v_mul_f32 v77, s35, v77
    v_mul_f32 v78, s35, v78
    v_mul_f32 v79, s35, v79
    v_cvt_pk_bf16_f32 v32, v64, v65
    v_cvt_pk_bf16_f32 v33, v66, v67
    v_cvt_pk_bf16_f32 v34, v68, v69
    v_cvt_pk_bf16_f32 v35, v70, v71
    v_cvt_pk_bf16_f32 v36, v72, v73
    v_cvt_pk_bf16_f32 v37, v74, v75
    v_cvt_pk_bf16_f32 v38, v76, v77
    v_cvt_pk_bf16_f32 v39, v78, v79
    v_cndmask_b32 v38, v38, v3, s[60:61]
    v_cndmask_b32 v39, v39, 0, s[60:61]
    s_add_u32 s50, s49, 0
    buffer_store_dwordx4 v[32:35], v2, s[20:23], s50 offen
    buffer_store_dwordx4 v[36:39], v2, s[20:23], s50 offen offset:1024
    s_nop 1
    v_mul_f32 v80, s35, v80
    v_mul_f32 v81, s35, v81
    v_mul_f32 v82, s35, v82
    v_mul_f32 v83, s35, v83
    v_mul_f32 v84, s35, v84
    v_mul_f32 v85, s35, v85
    v_mul_f32 v86, s35, v86
    v_mul_f32 v87, s35, v87
    v_mul_f32 v88, s35, v88
    v_mul_f32 v89, s35, v89
    v_mul_f32 v90, s35, v90
    v_mul_f32 v91, s35, v91
    v_mul_f32 v92, s35, v92
    v_mul_f32 v93, s35, v93
    v_mul_f32 v94, s35, v94
    v_mul_f32 v95, s35, v95
    v_cvt_pk_bf16_f32 v32, v80, v81
    v_cvt_pk_bf16_f32 v33, v82, v83
    v_cvt_pk_bf16_f32 v34, v84, v85
    v_cvt_pk_bf16_f32 v35, v86, v87
    v_cvt_pk_bf16_f32 v36, v88, v89
    v_cvt_pk_bf16_f32 v37, v90, v91
    v_cvt_pk_bf16_f32 v38, v92, v93
    v_cvt_pk_bf16_f32 v39, v94, v95
    v_cndmask_b32 v38, v38, v3, s[60:61]
    v_cndmask_b32 v39, v39, 0, s[60:61]
    s_add_u32 s50, s49, 2048
    buffer_store_dwordx4 v[32:35], v2, s[20:23], s50 offen
    buffer_store_dwordx4 v[36:39], v2, s[20:23], s50 offen offset:1024
    s_nop 1
    s_branch K1_RSTORE
K1_LOOP_V:
    s_setprio 2
    ds_read_b128 v[44:47], v11 offset:0
    ds_read_b128 v[48:51], v11 offset:4096
    ds_read_b64_tr_b16 v[52:53], v14 offset:20480
    ds_read_b64_tr_b16 v[54:55], v14 offset:21504
    s_waitcnt lgkmcnt(4)
    v_mfma_f32_32x32x16_bf16 v[64:79], v[32:35], v[40:43], 0
    v_mfma_f32_32x32x16_bf16 v[80:95], v[36:39], v[40:43], 0
    s_setprio 1
    ds_read_b128 v[32:35], v10 offset:1024
    ds_read_b128 v[36:39], v10 offset:5120
    ds_read_b64_tr_b16 v[40:41], v14 offset:24576
    ds_read_b64_tr_b16 v[42:43], v14 offset:25600
    s_waitcnt lgkmcnt(4)
    v_mfma_f32_32x32x16_bf16 v[64:79], v[44:47], v[52:55], v[64:79]
    v_mfma_f32_32x32x16_bf16 v[80:95], v[48:51], v[52:55], v[80:95]
    s_setprio 0
    ds_read_b128 v[44:47], v11 offset:1024
    ds_read_b128 v[48:51], v11 offset:5120
    ds_read_b64_tr_b16 v[52:53], v14 offset:28672
    ds_read_b64_tr_b16 v[54:55], v14 offset:29696
    s_waitcnt lgkmcnt(4)
    v_mfma_f32_32x32x16_bf16 v[64:79], v[32:35], v[40:43], v[64:79]
    v_mfma_f32_32x32x16_bf16 v[80:95], v[36:39], v[40:43], v[80:95]
    s_waitcnt vmcnt(20)
    s_barrier
    s_setprio 3
    s_mov_b32 s30, 384
    s_mul_i32 s31, s33, 3
    s_add_u32 m0, s32, 98304
    s_nop 0
    buffer_load_dwordx4 v2, s[12:15], s30 offen lds
    s_add_u32 m0, s32, 99328
    s_nop 0
    buffer_load_dwordx4 v3, s[12:15], s30 offen lds
    s_add_u32 m0, s32, 114688
    s_nop 0
    buffer_load_dwordx4 v6, s[16:19], s31 offen lds
    s_add_u32 m0, s32, 115712
    s_nop 0
    buffer_load_dwordx4 v7, s[16:19], s31 offen lds
    ds_read_b128 v[32:35], v10 offset:32768
    ds_read_b128 v[36:39], v10 offset:36864
    ds_read_b64_tr_b16 v[40:41], v14 offset:49152
    ds_read_b64_tr_b16 v[42:43], v14 offset:50176
    s_waitcnt lgkmcnt(4)
    v_mfma_f32_32x32x16_bf16 v[64:79], v[44:47], v[52:55], v[64:79]
    v_mfma_f32_32x32x16_bf16 v[80:95], v[48:51], v[52:55], v[80:95]
    s_setprio 2
    ds_read_b128 v[44:47], v11 offset:32768
    ds_read_b128 v[48:51], v11 offset:36864
    ds_read_b64_tr_b16 v[52:53], v14 offset:53248
    ds_read_b64_tr_b16 v[54:55], v14 offset:54272
    s_waitcnt lgkmcnt(4)
    v_mfma_f32_32x32x16_bf16 v[64:79], v[32:35], v[40:43], v[64:79]
    v_mfma_f32_32x32x16_bf16 v[80:95], v[36:39], v[40:43], v[80:95]
    s_setprio 1
    ds_read_b128 v[32:35], v10 offset:33792
    ds_read_b128 v[36:39], v10 offset:37888
    ds_read_b64_tr_b16 v[40:41], v14 offset:57344
    ds_read_b64_tr_b16 v[42:43], v14 offset:58368
    s_waitcnt lgkmcnt(4)
    v_mfma_f32_32x32x16_bf16 v[64:79], v[44:47], v[52:55], v[64:79]
    v_mfma_f32_32x32x16_bf16 v[80:95], v[48:51], v[52:55], v[80:95]
    s_setprio 0
    ds_read_b128 v[44:47], v11 offset:33792
    ds_read_b128 v[48:51], v11 offset:37888
    ds_read_b64_tr_b16 v[52:53], v14 offset:61440
    ds_read_b64_tr_b16 v[54:55], v14 offset:62464
    s_waitcnt lgkmcnt(4)
    v_mfma_f32_32x32x16_bf16 v[64:79], v[32:35], v[40:43], v[64:79]
    v_mfma_f32_32x32x16_bf16 v[80:95], v[36:39], v[40:43], v[80:95]
    s_waitcnt vmcnt(20)
    s_barrier
    s_setprio 3
    s_mov_b32 s30, 512
    s_mul_i32 s31, s33, 4
    s_add_u32 m0, s32, 0
    s_nop 0
    buffer_load_dwordx4 v2, s[12:15], s30 offen lds
    s_add_u32 m0, s32, 1024
    s_nop 0
    buffer_load_dwordx4 v3, s[12:15], s30 offen lds
    s_add_u32 m0, s32, 16384
    s_nop 0
    buffer_load_dwordx4 v6, s[16:19], s31 offen lds
    s_add_u32 m0, s32, 17408
    s_nop 0
    buffer_load_dwordx4 v7, s[16:19], s31 offen lds
    ds_read_b128 v[32:35], v12 offset:0
    ds_read_b128 v[36:39], v12 offset:4096
    ds_read_b64_tr_b16 v[40:41], v15 offset:16384
    ds_read_b64_tr_b16 v[42:43], v15 offset:17408
    s_waitcnt lgkmcnt(4)
    v_mfma_f32_32x32x16_bf16 v[64:79], v[44:47], v[52:55], v[64:79]
    v_mfma_f32_32x32x16_bf16 v[80:95], v[48:51], v[52:55], v[80:95]
    s_setprio 2
    ds_read_b128 v[44:47], v13 offset:0
    ds_read_b128 v[48:51], v13 offset:4096
    ds_read_b64_tr_b16 v[52:53], v15 offset:20480
    ds_read_b64_tr_b16 v[54:55], v15 offset:21504
    s_waitcnt lgkmcnt(4)
    v_mfma_f32_32x32x16_bf16 v[64:79], v[32:35], v[40:43], v[64:79]
    v_mfma_f32_32x32x16_bf16 v[80:95], v[36:39], v[40:43], v[80:95]
    s_setprio 1
    ds_read_b128 v[32:35], v12 offset:1024
    ds_read_b128 v[36:39], v12 offset:5120
    ds_read_b64_tr_b16 v[40:41], v15 offset:24576
    ds_read_b64_tr_b16 v[42:43], v15 offset:25600
    s_waitcnt lgkmcnt(4)
    v_mfma_f32_32x32x16_bf16 v[64:79], v[44:47], v[52:55], v[64:79]
    v_mfma_f32_32x32x16_bf16 v[80:95], v[48:51], v[52:55], v[80:95]
    s_setprio 0
    ds_read_b128 v[44:47], v13 offset:1024
    ds_read_b128 v[48:51], v13 offset:5120
    ds_read_b64_tr_b16 v[52:53], v15 offset:28672
    ds_read_b64_tr_b16 v[54:55], v15 offset:29696
    s_waitcnt lgkmcnt(4)
    v_mfma_f32_32x32x16_bf16 v[64:79], v[32:35], v[40:43], v[64:79]
    v_mfma_f32_32x32x16_bf16 v[80:95], v[36:39], v[40:43], v[80:95]
    s_waitcnt vmcnt(4)
    s_barrier
    s_setprio 3
    s_mov_b32 s30, 640
    s_mul_i32 s31, s33, 5
    s_add_u32 m0, s32, 32768
    s_nop 0
    buffer_load_dwordx4 v2, s[12:15], s30 offen lds
    s_add_u32 m0, s32, 33792
    s_nop 0
    buffer_load_dwordx4 v3, s[12:15], s30 offen lds
    s_add_u32 m0, s32, 49152
    s_nop 0
    buffer_load_dwordx4 v6, s[16:19], s31 offen lds
    s_add_u32 m0, s32, 50176
    s_nop 0
    buffer_load_dwordx4 v7, s[16:19], s31 offen lds
    ds_read_b128 v[32:35], v12 offset:32768
    ds_read_b128 v[36:39], v12 offset:36864
    ds_read_b64_tr_b16 v[40:41], v15 offset:49152
    ds_read_b64_tr_b16 v[42:43], v15 offset:50176
    s_waitcnt lgkmcnt(4)
    v_mfma_f32_32x32x16_bf16 v[64:79], v[44:47], v[52:55], v[64:79]
    v_mfma_f32_32x32x16_bf16 v[80:95], v[48:51], v[52:55], v[80:95]
    s_setprio 2
    ds_read_b128 v[44:47], v13 offset:32768
    ds_read_b128 v[48:51], v13 offset:36864
    ds_read_b64_tr_b16 v[52:53], v15 offset:53248
    ds_read_b64_tr_b16 v[54:55], v15 offset:54272
    s_waitcnt lgkmcnt(4)
    v_mfma_f32_32x32x16_bf16 v[64:79], v[32:35], v[40:43], v[64:79]
    v_mfma_f32_32x32x16_bf16 v[80:95], v[36:39], v[40:43], v[80:95]
    s_setprio 1
    ds_read_b128 v[32:35], v12 offset:33792
    ds_read_b128 v[36:39], v12 offset:37888
    ds_read_b64_tr_b16 v[40:41], v15 offset:57344
    ds_read_b64_tr_b16 v[42:43], v15 offset:58368
    s_waitcnt lgkmcnt(4)
    v_mfma_f32_32x32x16_bf16 v[64:79], v[44:47], v[52:55], v[64:79]
    v_mfma_f32_32x32x16_bf16 v[80:95], v[48:51], v[52:55], v[80:95]
    s_setprio 0
    ds_read_b128 v[44:47], v13 offset:33792
    ds_read_b128 v[48:51], v13 offset:37888
    ds_read_b64_tr_b16 v[52:53], v15 offset:61440
    ds_read_b64_tr_b16 v[54:55], v15 offset:62464
    s_waitcnt lgkmcnt(4)
    v_mfma_f32_32x32x16_bf16 v[64:79], v[32:35], v[40:43], v[64:79]
    v_mfma_f32_32x32x16_bf16 v[80:95], v[36:39], v[40:43], v[80:95]
    s_waitcnt vmcnt(4)
    s_barrier
    s_setprio 3
    s_mov_b32 s30, 768
    s_mul_i32 s31, s33, 6
    s_add_u32 m0, s32, 65536
    s_nop 0
    buffer_load_dwordx4 v2, s[12:15], s30 offen lds
    s_add_u32 m0, s32, 66560
    s_nop 0
    buffer_load_dwordx4 v3, s[12:15], s30 offen lds
    s_add_u32 m0, s32, 81920
    s_nop 0
    buffer_load_dwordx4 v6, s[16:19], s31 offen lds
    s_add_u32 m0, s32, 82944
    s_nop 0
    buffer_load_dwordx4 v7, s[16:19], s31 offen lds
    ds_read_b128 v[32:35], v10 offset:0
    ds_read_b128 v[36:39], v10 offset:4096
    ds_read_b64_tr_b16 v[40:41], v14 offset:16384
    ds_read_b64_tr_b16 v[42:43], v14 offset:17408
    s_waitcnt lgkmcnt(4)
    v_mfma_f32_32x32x16_bf16 v[64:79], v[44:47], v[52:55], v[64:79]
    v_mfma_f32_32x32x16_bf16 v[80:95], v[48:51], v[52:55], v[80:95]
    s_setprio 2
    ds_read_b128 v[44:47], v11 offset:0
    ds_read_b128 v[48:51], v11 offset:4096
    ds_read_b64_tr_b16 v[52:53], v14 offset:20480
    ds_read_b64_tr_b16 v[54:55], v14 offset:21504
    s_waitcnt lgkmcnt(4)
    v_mfma_f32_32x32x16_bf16 v[64:79], v[32:35], v[40:43], v[64:79]
    v_mfma_f32_32x32x16_bf16 v[80:95], v[36:39], v[40:43], v[80:95]
    s_setprio 1
    ds_read_b128 v[32:35], v10 offset:1024
    ds_read_b128 v[36:39], v10 offset:5120
    ds_read_b64_tr_b16 v[40:41], v14 offset:24576
    ds_read_b64_tr_b16 v[42:43], v14 offset:25600
    s_waitcnt lgkmcnt(4)
    v_mfma_f32_32x32x16_bf16 v[64:79], v[44:47], v[52:55], v[64:79]
    v_mfma_f32_32x32x16_bf16 v[80:95], v[48:51], v[52:55], v[80:95]
    s_setprio 0
    ds_read_b128 v[44:47], v11 offset:1024
    ds_read_b128 v[48:51], v11 offset:5120
    ds_read_b64_tr_b16 v[52:53], v14 offset:28672
    ds_read_b64_tr_b16 v[54:55], v14 offset:29696
    s_waitcnt lgkmcnt(4)
    v_mfma_f32_32x32x16_bf16 v[64:79], v[32:35], v[40:43], v[64:79]
    v_mfma_f32_32x32x16_bf16 v[80:95], v[36:39], v[40:43], v[80:95]
    s_waitcnt vmcnt(4)
    s_barrier
    s_setprio 3
    ds_read_b128 v[32:35], v10 offset:32768
    ds_read_b128 v[36:39], v10 offset:36864
    ds_read_b64_tr_b16 v[40:41], v14 offset:49152
    ds_read_b64_tr_b16 v[42:43], v14 offset:50176
    s_waitcnt lgkmcnt(4)
    v_mfma_f32_32x32x16_bf16 v[64:79], v[44:47], v[52:55], v[64:79]
    v_mfma_f32_32x32x16_bf16 v[80:95], v[48:51], v[52:55], v[80:95]
    s_setprio 2
    ds_read_b128 v[44:47], v11 offset:32768
    ds_read_b128 v[48:51], v11 offset:36864
    ds_read_b64_tr_b16 v[52:53], v14 offset:53248
    ds_read_b64_tr_b16 v[54:55], v14 offset:54272
    s_waitcnt lgkmcnt(4)
    v_mfma_f32_32x32x16_bf16 v[64:79], v[32:35], v[40:43], v[64:79]
    v_mfma_f32_32x32x16_bf16 v[80:95], v[36:39], v[40:43], v[80:95]
    s_setprio 1
    ds_read_b128 v[32:35], v10 offset:33792
    ds_read_b128 v[36:39], v10 offset:37888
    ds_read_b64_tr_b16 v[40:41], v14 offset:57344
    ds_read_b64_tr_b16 v[42:43], v14 offset:58368
    s_waitcnt lgkmcnt(4)
    v_mfma_f32_32x32x16_bf16 v[64:79], v[44:47], v[52:55], v[64:79]
    v_mfma_f32_32x32x16_bf16 v[80:95], v[48:51], v[52:55], v[80:95]
    s_setprio 0
    ds_read_b128 v[44:47], v11 offset:33792
    ds_read_b128 v[48:51], v11 offset:37888
    ds_read_b64_tr_b16 v[52:53], v14 offset:61440
    ds_read_b64_tr_b16 v[54:55], v14 offset:62464
    s_waitcnt lgkmcnt(4)
    v_mfma_f32_32x32x16_bf16 v[64:79], v[32:35], v[40:43], v[64:79]
    v_mfma_f32_32x32x16_bf16 v[80:95], v[36:39], v[40:43], v[80:95]
    s_waitcnt vmcnt(0)
    s_barrier
    s_setprio 3
    ds_read_b128 v[32:35], v12 offset:0
    ds_read_b128 v[36:39], v12 offset:4096
    ds_read_b64_tr_b16 v[40:41], v15 offset:16384
    ds_read_b64_tr_b16 v[42:43], v15 offset:17408
    s_waitcnt lgkmcnt(4)
    v_mfma_f32_32x32x16_bf16 v[64:79], v[44:47], v[52:55], v[64:79]
    v_mfma_f32_32x32x16_bf16 v[80:95], v[48:51], v[52:55], v[80:95]
    s_setprio 2
    ds_read_b128 v[44:47], v13 offset:0
    ds_read_b128 v[48:51], v13 offset:4096
    ds_read_b64_tr_b16 v[52:53], v15 offset:20480
    ds_read_b64_tr_b16 v[54:55], v15 offset:21504
    s_waitcnt lgkmcnt(4)
    v_mfma_f32_32x32x16_bf16 v[64:79], v[32:35], v[40:43], v[64:79]
    v_mfma_f32_32x32x16_bf16 v[80:95], v[36:39], v[40:43], v[80:95]
    s_setprio 1
    ds_read_b128 v[32:35], v12 offset:1024
    ds_read_b128 v[36:39], v12 offset:5120
    ds_read_b64_tr_b16 v[40:41], v15 offset:24576
    ds_read_b64_tr_b16 v[42:43], v15 offset:25600
    s_waitcnt lgkmcnt(4)
    v_mfma_f32_32x32x16_bf16 v[64:79], v[44:47], v[52:55], v[64:79]
    v_mfma_f32_32x32x16_bf16 v[80:95], v[48:51], v[52:55], v[80:95]
    s_setprio 0
    ds_read_b128 v[44:47], v13 offset:1024
    ds_read_b128 v[48:51], v13 offset:5120
    ds_read_b64_tr_b16 v[52:53], v15 offset:28672
    ds_read_b64_tr_b16 v[54:55], v15 offset:29696
    s_waitcnt lgkmcnt(4)
    v_mfma_f32_32x32x16_bf16 v[64:79], v[32:35], v[40:43], v[64:79]
    v_mfma_f32_32x32x16_bf16 v[80:95], v[36:39], v[40:43], v[80:95]
    s_waitcnt lgkmcnt(0)
    v_mfma_f32_32x32x16_bf16 v[64:79], v[44:47], v[52:55], v[64:79]
    v_mfma_f32_32x32x16_bf16 v[80:95], v[48:51], v[52:55], v[80:95]
    s_lshl_b32 s49, s25, 19
    s_lshl_b32 s50, s53, 17
    s_add_u32 s49, s49, s50
    s_lshl_b32 s50, s24, 13
    s_add_u32 s49, s49, s50
    s_lshl_b32 s50, s52, 12
    s_add_u32 s49, s49, s50
    v_lshlrev_b32 v2, 4, v1
    v_and_b32 v3, 31, v1
    v_cmp_le_u32 s[62:63], 28, v3
    v_cmp_eq_u32 vcc, 28, v3
    s_nop 1
    v_cndmask_b32 v3, 0, v18, vcc
    s_nop 7
    v_cvt_pk_bf16_f32 v32, v64, v65
    v_cvt_pk_bf16_f32 v33, v66, v67
    v_cvt_pk_bf16_f32 v34, v68, v69
    v_cvt_pk_bf16_f32 v35, v70, v71
    v_cvt_pk_bf16_f32 v36, v72, v73
    v_cvt_pk_bf16_f32 v37, v74, v75
    v_cvt_pk_bf16_f32 v38, v76, v77
    v_cvt_pk_bf16_f32 v39, v78, v79
    v_cndmask_b32 v32, v32, v3, s[62:63]
    v_cndmask_b32 v33, v33, v3, s[62:63]
    v_cndmask_b32 v34, v34, v3, s[62:63]
    v_cndmask_b32 v35, v35, v3, s[62:63]
    v_cndmask_b32 v36, v36, v3, s[62:63]
    v_cndmask_b32 v37, v37, v3, s[62:63]
    v_cndmask_b32 v38, v38, v3, s[62:63]
    v_cndmask_b32 v39, v39, v3, s[62:63]
    s_add_u32 s50, s49, 0
    buffer_store_dwordx4 v[32:35], v2, s[20:23], s50 offen
    buffer_store_dwordx4 v[36:39], v2, s[20:23], s50 offen offset:1024
    s_nop 1
    v_cvt_pk_bf16_f32 v32, v80, v81
    v_cvt_pk_bf16_f32 v33, v82, v83
    v_cvt_pk_bf16_f32 v34, v84, v85
    v_cvt_pk_bf16_f32 v35, v86, v87
    v_cvt_pk_bf16_f32 v36, v88, v89
    v_cvt_pk_bf16_f32 v37, v90, v91
    v_cvt_pk_bf16_f32 v38, v92, v93
    v_cvt_pk_bf16_f32 v39, v94, v95
    v_cndmask_b32 v32, v32, v3, s[62:63]
    v_cndmask_b32 v33, v33, v3, s[62:63]
    v_cndmask_b32 v34, v34, v3, s[62:63]
    v_cndmask_b32 v35, v35, v3, s[62:63]
    v_cndmask_b32 v36, v36, v3, s[62:63]
    v_cndmask_b32 v37, v37, v3, s[62:63]
    v_cndmask_b32 v38, v38, v3, s[62:63]
    v_cndmask_b32 v39, v39, v3, s[62:63]
    s_add_u32 s50, s49, 2048
    buffer_store_dwordx4 v[32:35], v2, s[20:23], s50 offen
    buffer_store_dwordx4 v[36:39], v2, s[20:23], s50 offen offset:1024
    s_nop 1
    s_branch K1_RSTORE
K1_LOOP_H:
    s_setprio 2
    ds_read_b128 v[44:47], v11 offset:0
    ds_read_b128 v[48:51], v11 offset:4096
    ds_read_b64_tr_b16 v[52:53], v14 offset:20480
    ds_read_b64_tr_b16 v[54:55], v14 offset:21504
    s_waitcnt lgkmcnt(4)
    v_mfma_f32_32x32x16_bf16 v[64:79], v[40:43], v[32:35], 0
    v_mfma_f32_32x32x16_bf16 v[80:95], v[40:43], v[36:39], 0
    s_cmp_lg_u32 s53, 0
    s_cbranch_scc1 K1H_S0_0a
    v_dot2_f32_bf16 v20, v32, v18, v20
    v_dot2_f32_bf16 v22, v32, v32, v22
    v_dot2_f32_bf16 v20, v33, v18, v20
    v_dot2_f32_bf16 v22, v33, v33, v22
    v_dot2_f32_bf16 v20, v34, v18, v20
    v_dot2_f32_bf16 v22, v34, v34, v22
    v_dot2_f32_bf16 v20, v35, v18, v20
    v_dot2_f32_bf16 v22, v35, v35, v22
    v_dot2_f32_bf16 v21, v36, v18, v21
    v_dot2_f32_bf16 v23, v36, v36, v23
    v_dot2_f32_bf16 v21, v37, v18, v21
    v_dot2_f32_bf16 v23, v37, v37, v23
    v_dot2_f32_bf16 v21, v38, v18, v21
    v_dot2_f32_bf16 v23, v38, v38, v23
    v_dot2_f32_bf16 v21, v39, v18, v21
    v_dot2_f32_bf16 v23, v39, v39, v23
K1H_S0_0a:
    s_cmp_lg_u32 s52, 0
    s_cbranch_scc1 K1H_S0_0b
    v_dot2_f32_bf16 v24, v40, v18, v24
    v_dot2_f32_bf16 v24, v41, v18, v24
    v_dot2_f32_bf16 v24, v42, v18, v24
    v_dot2_f32_bf16 v24, v43, v18, v24
K1H_S0_0b:
    s_cmp_eq_u32 s54, 0
    s_cbranch_scc1 K1H_S0_0c
    v_dot2_f32_bf16 v25, v32, v128, v25
    v_dot2_f32_bf16 v25, v33, v129, v25
    v_dot2_f32_bf16 v25, v34, v130, v25
    v_dot2_f32_bf16 v25, v35, v131, v25
    v_dot2_f32_bf16 v26, v36, v128, v26
    v_dot2_f32_bf16 v26, v37, v129, v26
    v_dot2_f32_bf16 v26, v38, v130, v26
    v_dot2_f32_bf16 v26, v39, v131, v26
K1H_S0_0c:
    s_setprio 1
    ds_read_b128 v[32:35], v10 offset:1024
    ds_read_b128 v[36:39], v10 offset:5120
    ds_read_b64_tr_b16 v[40:41], v14 offset:24576
    ds_read_b64_tr_b16 v[42:43], v14 offset:25600
    s_waitcnt lgkmcnt(4)
    v_mfma_f32_32x32x16_bf16 v[64:79], v[52:55], v[44:47], v[64:79]
    v_mfma_f32_32x32x16_bf16 v[80:95], v[52:55], v[48:51], v[80:95]
    s_cmp_lg_u32 s53, 1
    s_cbranch_scc1 K1H_S0_1a
    v_dot2_f32_bf16 v20, v44, v18, v20
    v_dot2_f32_bf16 v22, v44, v44, v22
    v_dot2_f32_bf16 v20, v45, v18, v20
    v_dot2_f32_bf16 v22, v45, v45, v22
    v_dot2_f32_bf16 v20, v46, v18, v20
    v_dot2_f32_bf16 v22, v46, v46, v22
    v_dot2_f32_bf16 v20, v47, v18, v20
    v_dot2_f32_bf16 v22, v47, v47, v22
    v_dot2_f32_bf16 v21, v48, v18, v21
    v_dot2_f32_bf16 v23, v48, v48, v23
    v_dot2_f32_bf16 v21, v49, v18, v21
    v_dot2_f32_bf16 v23, v49, v49, v23
    v_dot2_f32_bf16 v21, v50, v18, v21
    v_dot2_f32_bf16 v23, v50, v50, v23
    v_dot2_f32_bf16 v21, v51, v18, v21
    v_dot2_f32_bf16 v23, v51, v51, v23
K1H_S0_1a:
    s_cmp_lg_u32 s52, 1
    s_cbranch_scc1 K1H_S0_1b
    v_dot2_f32_bf16 v24, v52, v18, v24
    v_dot2_f32_bf16 v24, v53, v18, v24
    v_dot2_f32_bf16 v24, v54, v18, v24
    v_dot2_f32_bf16 v24, v55, v18, v24
K1H_S0_1b:
    s_cmp_eq_u32 s54, 0
    s_cbranch_scc1 K1H_S0_1c
    v_dot2_f32_bf16 v25, v44, v132, v25
    v_dot2_f32_bf16 v25, v45, v133, v25
    v_dot2_f32_bf16 v25, v46, v134, v25
    v_dot2_f32_bf16 v25, v47, v135, v25
    v_dot2_f32_bf16 v26, v48, v132, v26
    v_dot2_f32_bf16 v26, v49, v133, v26
    v_dot2_f32_bf16 v26, v50, v134, v26
    v_dot2_f32_bf16 v26, v51, v135, v26
K1H_S0_1c:
    s_setprio 0
    ds_read_b128 v[44:47], v11 offset:1024
    ds_read_b128 v[48:51], v11 offset:5120
    ds_read_b64_tr_b16 v[52:53], v14 offset:28672
    ds_read_b64_tr_b16 v[54:55], v14 offset:29696
    s_waitcnt lgkmcnt(4)
    v_mfma_f32_32x32x16_bf16 v[64:79], v[40:43], v[32:35], v[64:79]
    v_mfma_f32_32x32x16_bf16 v[80:95], v[40:43], v[36:39], v[80:95]
    s_cmp_lg_u32 s53, 2
    s_cbranch_scc1 K1H_S0_2a
    v_dot2_f32_bf16 v20, v32, v18, v20
    v_dot2_f32_bf16 v22, v32, v32, v22
    v_dot2_f32_bf16 v20, v33, v18, v20
    v_dot2_f32_bf16 v22, v33, v33, v22
    v_dot2_f32_bf16 v20, v34, v18, v20
    v_dot2_f32_bf16 v22, v34, v34, v22
    v_dot2_f32_bf16 v20, v35, v18, v20
    v_dot2_f32_bf16 v22, v35, v35, v22
    v_dot2_f32_bf16 v21, v36, v18, v21
    v_dot2_f32_bf16 v23, v36, v36, v23
    v_dot2_f32_bf16 v21, v37, v18, v21
    v_dot2_f32_bf16 v23, v37, v37, v23
    v_dot2_f32_bf16 v21, v38, v18, v21
    v_dot2_f32_bf16 v23, v38, v38, v23
    v_dot2_f32_bf16 v21, v39, v18, v21
    v_dot2_f32_bf16 v23, v39, v39, v23
K1H_S0_2a:
    s_cmp_lg_u32 s52, 0
    s_cbranch_scc1 K1H_S0_2b
    v_dot2_f32_bf16 v24, v40, v18, v24
    v_dot2_f32_bf16 v24, v41, v18, v24
    v_dot2_f32_bf16 v24, v42, v18, v24
    v_dot2_f32_bf16 v24, v43, v18, v24
K1H_S0_2b:
    s_cmp_eq_u32 s54, 0
    s_cbranch_scc1 K1H_S0_2c
    v_dot2_f32_bf16 v25, v32, v136, v25
    v_dot2_f32_bf16 v25, v33, v137, v25
    v_dot2_f32_bf16 v25, v34, v138, v25
    v_dot2_f32_bf16 v25, v35, v139, v25
    v_dot2_f32_bf16 v26, v36, v136, v26
    v_dot2_f32_bf16 v26, v37, v137, v26
    v_dot2_f32_bf16 v26, v38, v138, v26
    v_dot2_f32_bf16 v26, v39, v139, v26
K1H_S0_2c:
    s_waitcnt vmcnt(20)
    s_barrier
    s_setprio 3
    s_mov_b32 s30, 384
    s_mul_i32 s31, s33, 3
    s_add_u32 m0, s32, 98304
    s_nop 0
    buffer_load_dwordx4 v2, s[12:15], s30 offen lds
    s_add_u32 m0, s32, 99328
    s_nop 0
    buffer_load_dwordx4 v3, s[12:15], s30 offen lds
    s_add_u32 m0, s32, 114688
    s_nop 0
    buffer_load_dwordx4 v6, s[16:19], s31 offen lds
    s_add_u32 m0, s32, 115712
    s_nop 0
    buffer_load_dwordx4 v7, s[16:19], s31 offen lds
    ds_read_b128 v[32:35], v10 offset:32768
    ds_read_b128 v[36:39], v10 offset:36864
    ds_read_b64_tr_b16 v[40:41], v14 offset:49152
    ds_read_b64_tr_b16 v[42:43], v14 offset:50176
    s_waitcnt lgkmcnt(4)
    v_mfma_f32_32x32x16_bf16 v[64:79], v[52:55], v[44:47], v[64:79]
    v_mfma_f32_32x32x16_bf16 v[80:95], v[52:55], v[48:51], v[80:95]
    s_cmp_lg_u32 s53, 3
    s_cbranch_scc1 K1H_S0_3a
    v_dot2_f32_bf16 v20, v44, v18, v20
    v_dot2_f32_bf16 v22, v44, v44, v22
    v_dot2_f32_bf16 v20, v45, v18, v20
    v_dot2_f32_bf16 v22, v45, v45, v22
    v_dot2_f32_bf16 v20, v46, v18, v20
    v_dot2_f32_bf16 v22, v46, v46, v22
    v_dot2_f32_bf16 v20, v47, v18, v20
    v_dot2_f32_bf16 v22, v47, v47, v22
    v_dot2_f32_bf16 v21, v48, v18, v21
    v_dot2_f32_bf16 v23, v48, v48, v23
    v_dot2_f32_bf16 v21, v49, v18, v21
    v_dot2_f32_bf16 v23, v49, v49, v23
    v_dot2_f32_bf16 v21, v50, v18, v21
    v_dot2_f32_bf16 v23, v50, v50, v23
    v_dot2_f32_bf16 v21, v51, v18, v21
    v_dot2_f32_bf16 v23, v51, v51, v23
K1H_S0_3a:
    s_cmp_lg_u32 s52, 1
    s_cbranch_scc1 K1H_S0_3b
    v_dot2_f32_bf16 v24, v52, v18, v24
    v_dot2_f32_bf16 v24, v53, v18, v24
    v_dot2_f32_bf16 v24, v54, v18, v24
    v_dot2_f32_bf16 v24, v55, v18, v24
K1H_S0_3b:
    s_cmp_eq_u32 s54, 0
    s_cbranch_scc1 K1H_S0_3c
    v_dot2_f32_bf16 v25, v44, v140, v25
    v_dot2_f32_bf16 v25, v45, v141, v25
    v_dot2_f32_bf16 v25, v46, v142, v25
    v_dot2_f32_bf16 v25, v47, v143, v25
    v_dot2_f32_bf16 v26, v48, v140, v26
    v_dot2_f32_bf16 v26, v49, v141, v26
    v_dot2_f32_bf16 v26, v50, v142, v26
    v_dot2_f32_bf16 v26, v51, v143, v26
K1H_S0_3c:
    s_setprio 2
    ds_read_b128 v[44:47], v11 offset:32768
    ds_read_b128 v[48:51], v11 offset:36864
    ds_read_b64_tr_b16 v[52:53], v14 offset:53248
    ds_read_b64_tr_b16 v[54:55], v14 offset:54272
    s_waitcnt lgkmcnt(4)
    v_mfma_f32_32x32x16_bf16 v[64:79], v[40:43], v[32:35], v[64:79]
    v_mfma_f32_32x32x16_bf16 v[80:95], v[40:43], v[36:39], v[80:95]
    s_cmp_lg_u32 s53, 0
    s_cbranch_scc1 K1H_S1_0a
    v_dot2_f32_bf16 v20, v32, v18, v20
    v_dot2_f32_bf16 v22, v32, v32, v22
    v_dot2_f32_bf16 v20, v33, v18, v20
    v_dot2_f32_bf16 v22, v33, v33, v22
    v_dot2_f32_bf16 v20, v34, v18, v20
    v_dot2_f32_bf16 v22, v34, v34, v22
    v_dot2_f32_bf16 v20, v35, v18, v20
    v_dot2_f32_bf16 v22, v35, v35, v22
    v_dot2_f32_bf16 v21, v36, v18, v21
    v_dot2_f32_bf16 v23, v36, v36, v23
    v_dot2_f32_bf16 v21, v37, v18, v21
    v_dot2_f32_bf16 v23, v37, v37, v23
    v_dot2_f32_bf16 v21, v38, v18, v21
    v_dot2_f32_bf16 v23, v38, v38, v23
    v_dot2_f32_bf16 v21, v39, v18, v21
    v_dot2_f32_bf16 v23, v39, v39, v23
K1H_S1_0a:
    s_cmp_lg_u32 s52, 0
    s_cbranch_scc1 K1H_S1_0b
    v_dot2_f32_bf16 v24, v40, v18, v24
    v_dot2_f32_bf16 v24, v41, v18, v24
    v_dot2_f32_bf16 v24, v42, v18, v24
    v_dot2_f32_bf16 v24, v43, v18, v24
K1H_S1_0b:
    s_cmp_eq_u32 s54, 0
    s_cbranch_scc1 K1H_S1_0c
    v_dot2_f32_bf16 v25, v32, v144, v25
    v_dot2_f32_bf16 v25, v33, v145, v25
    v_dot2_f32_bf16 v25, v34, v146, v25
    v_dot2_f32_bf16 v25, v35, v147, v25
    v_dot2_f32_bf16 v26, v36, v144, v26
    v_dot2_f32_bf16 v26, v37, v145, v26
    v_dot2_f32_bf16 v26, v38, v146, v26
    v_dot2_f32_bf16 v26, v39, v147, v26
K1H_S1_0c:
    s_setprio 1
    ds_read_b128 v[32:35], v10 offset:33792
    ds_read_b128 v[36:39], v10 offset:37888
    ds_read_b64_tr_b16 v[40:41], v14 offset:57344
    ds_read_b64_tr_b16 v[42:43], v14 offset:58368
    s_waitcnt lgkmcnt(4)
    v_mfma_f32_32x32x16_bf16 v[64:79], v[52:55], v[44:47], v[64:79]
    v_mfma_f32_32x32x16_bf16 v[80:95], v[52:55], v[48:51], v[80:95]
    s_cmp_lg_u32 s53, 1
    s_cbranch_scc1 K1H_S1_1a
    v_dot2_f32_bf16 v20, v44, v18, v20
    v_dot2_f32_bf16 v22, v44, v44, v22
    v_dot2_f32_bf16 v20, v45, v18, v20
    v_dot2_f32_bf16 v22, v45, v45, v22
    v_dot2_f32_bf16 v20, v46, v18, v20
    v_dot2_f32_bf16 v22, v46, v46, v22
    v_dot2_f32_bf16 v20, v47, v18, v20
    v_dot2_f32_bf16 v22, v47, v47, v22
    v_dot2_f32_bf16 v21, v48, v18, v21
    v_dot2_f32_bf16 v23, v48, v48, v23
    v_dot2_f32_bf16 v21, v49, v18, v21
    v_dot2_f32_bf16 v23, v49, v49, v23
    v_dot2_f32_bf16 v21, v50, v18, v21
    v_dot2_f32_bf16 v23, v50, v50, v23
    v_dot2_f32_bf16 v21, v51, v18, v21
    v_dot2_f32_bf16 v23, v51, v51, v23
K1H_S1_1a:
    s_cmp_lg_u32 s52, 1
    s_cbranch_scc1 K1H_S1_1b
    v_dot2_f32_bf16 v24, v52, v18, v24
    v_dot2_f32_bf16 v24, v53, v18, v24
    v_dot2_f32_bf16 v24, v54, v18, v24
    v_dot2_f32_bf16 v24, v55, v18, v24
K1H_S1_1b:
    s_cmp_eq_u32 s54, 0
    s_cbranch_scc1 K1H_S1_1c
    v_dot2_f32_bf16 v25, v44, v148, v25
    v_dot2_f32_bf16 v25, v45, v149, v25
    v_dot2_f32_bf16 v25, v46, v150, v25
    v_dot2_f32_bf16 v25, v47, v151, v25
    v_dot2_f32_bf16 v26, v48, v148, v26
    v_dot2_f32_bf16 v26, v49, v149, v26
    v_dot2_f32_bf16 v26, v50, v150, v26
    v_dot2_f32_bf16 v26, v51, v151, v26
K1H_S1_1c:
    s_setprio 0
    ds_read_b128 v[44:47], v11 offset:33792
    ds_read_b128 v[48:51], v11 offset:37888
    ds_read_b64_tr_b16 v[52:53], v14 offset:61440
    ds_read_b64_tr_b16 v[54:55], v14 offset:62464
    s_waitcnt lgkmcnt(4)
    v_mfma_f32_32x32x16_bf16 v[64:79], v[40:43], v[32:35], v[64:79]
    v_mfma_f32_32x32x16_bf16 v[80:95], v[40:43], v[36:39], v[80:95]
    s_cmp_lg_u32 s53, 2
    s_cbranch_scc1 K1H_S1_2a
    v_dot2_f32_bf16 v20, v32, v18, v20
    v_dot2_f32_bf16 v22, v32, v32, v22
    v_dot2_f32_bf16 v20, v33, v18, v20
    v_dot2_f32_bf16 v22, v33, v33, v22
    v_dot2_f32_bf16 v20, v34, v18, v20
    v_dot2_f32_bf16 v22, v34, v34, v22
    v_dot2_f32_bf16 v20, v35, v18, v20
    v_dot2_f32_bf16 v22, v35, v35, v22
    v_dot2_f32_bf16 v21, v36, v18, v21
    v_dot2_f32_bf16 v23, v36, v36, v23
    v_dot2_f32_bf16 v21, v37, v18, v21
    v_dot2_f32_bf16 v23, v37, v37, v23
    v_dot2_f32_bf16 v21, v38, v18, v21
    v_dot2_f32_bf16 v23, v38, v38, v23
    v_dot2_f32_bf16 v21, v39, v18, v21
    v_dot2_f32_bf16 v23, v39, v39, v23
K1H_S1_2a:
    s_cmp_lg_u32 s52, 0
    s_cbranch_scc1 K1H_S1_2b
    v_dot2_f32_bf16 v24, v40, v18, v24
    v_dot2_f32_bf16 v24, v41, v18, v24
    v_dot2_f32_bf16 v24, v42, v18, v24
    v_dot2_f32_bf16 v24, v43, v18, v24
K1H_S1_2b:
    s_cmp_eq_u32 s54, 0
    s_cbranch_scc1 K1H_S1_2c
    v_dot2_f32_bf16 v25, v32, v152, v25
    v_dot2_f32_bf16 v25, v33, v153, v25
    v_dot2_f32_bf16 v25, v34, v154, v25
    v_dot2_f32_bf16 v25, v35, v155, v25
    v_dot2_f32_bf16 v26, v36, v152, v26
    v_dot2_f32_bf16 v26, v37, v153, v26
    v_dot2_f32_bf16 v26, v38, v154, v26
    v_dot2_f32_bf16 v26, v39, v155, v26
K1H_S1_2c:
    s_waitcnt vmcnt(20)
    s_barrier
    s_setprio 3
    s_mov_b32 s30, 512
    s_mul_i32 s31, s33, 4
    s_add_u32 m0, s32, 0
    s_nop 0
    buffer_load_dwordx4 v2, s[12:15], s30 offen lds
    s_add_u32 m0, s32, 1024
    s_nop 0
    buffer_load_dwordx4 v3, s[12:15], s30 offen lds
    s_add_u32 m0, s32, 16384
    s_nop 0
    buffer_load_dwordx4 v6, s[16:19], s31 offen lds
    s_add_u32 m0, s32, 17408
    s_nop 0
    buffer_load_dwordx4 v7, s[16:19], s31 offen lds
    ds_read_b128 v[32:35], v12 offset:0
    ds_read_b128 v[36:39], v12 offset:4096
    ds_read_b64_tr_b16 v[40:41], v15 offset:16384
    ds_read_b64_tr_b16 v[42:43], v15 offset:17408
    s_waitcnt lgkmcnt(4)
    v_mfma_f32_32x32x16_bf16 v[64:79], v[52:55], v[44:47], v[64:79]
    v_mfma_f32_32x32x16_bf16 v[80:95], v[52:55], v[48:51], v[80:95]
    s_cmp_lg_u32 s53, 3
    s_cbranch_scc1 K1H_S1_3a
    v_dot2_f32_bf16 v20, v44, v18, v20
    v_dot2_f32_bf16 v22, v44, v44, v22
    v_dot2_f32_bf16 v20, v45, v18, v20
    v_dot2_f32_bf16 v22, v45, v45, v22
    v_dot2_f32_bf16 v20, v46, v18, v20
    v_dot2_f32_bf16 v22, v46, v46, v22
    v_dot2_f32_bf16 v20, v47, v18, v20
    v_dot2_f32_bf16 v22, v47, v47, v22
    v_dot2_f32_bf16 v21, v48, v18, v21
    v_dot2_f32_bf16 v23, v48, v48, v23
    v_dot2_f32_bf16 v21, v49, v18, v21
    v_dot2_f32_bf16 v23, v49, v49, v23
    v_dot2_f32_bf16 v21, v50, v18, v21
    v_dot2_f32_bf16 v23, v50, v50, v23
    v_dot2_f32_bf16 v21, v51, v18, v21
    v_dot2_f32_bf16 v23, v51, v51, v23
K1H_S1_3a:
    s_cmp_lg_u32 s52, 1
    s_cbranch_scc1 K1H_S1_3b
    v_dot2_f32_bf16 v24, v52, v18, v24
    v_dot2_f32_bf16 v24, v53, v18, v24
    v_dot2_f32_bf16 v24, v54, v18, v24
    v_dot2_f32_bf16 v24, v55, v18, v24
K1H_S1_3b:
    s_cmp_eq_u32 s54, 0
    s_cbranch_scc1 K1H_S1_3c
    v_dot2_f32_bf16 v25, v44, v156, v25
    v_dot2_f32_bf16 v25, v45, v157, v25
    v_dot2_f32_bf16 v25, v46, v158, v25
    v_dot2_f32_bf16 v25, v47, v159, v25
    v_dot2_f32_bf16 v26, v48, v156, v26
    v_dot2_f32_bf16 v26, v49, v157, v26
    v_dot2_f32_bf16 v26, v50, v158, v26
    v_dot2_f32_bf16 v26, v51, v159, v26
K1H_S1_3c:
    s_setprio 2
    ds_read_b128 v[44:47], v13 offset:0
    ds_read_b128 v[48:51], v13 offset:4096
    ds_read_b64_tr_b16 v[52:53], v15 offset:20480
    ds_read_b64_tr_b16 v[54:55], v15 offset:21504
    s_waitcnt lgkmcnt(4)
    v_mfma_f32_32x32x16_bf16 v[64:79], v[40:43], v[32:35], v[64:79]
    v_mfma_f32_32x32x16_bf16 v[80:95], v[40:43], v[36:39], v[80:95]
    s_cmp_lg_u32 s53, 0
    s_cbranch_scc1 K1H_S2_0a
    v_dot2_f32_bf16 v20, v32, v18, v20
    v_dot2_f32_bf16 v22, v32, v32, v22
    v_dot2_f32_bf16 v20, v33, v18, v20
    v_dot2_f32_bf16 v22, v33, v33, v22
    v_dot2_f32_bf16 v20, v34, v18, v20
    v_dot2_f32_bf16 v22, v34, v34, v22
    v_dot2_f32_bf16 v20, v35, v18, v20
    v_dot2_f32_bf16 v22, v35, v35, v22
    v_dot2_f32_bf16 v21, v36, v18, v21
    v_dot2_f32_bf16 v23, v36, v36, v23
    v_dot2_f32_bf16 v21, v37, v18, v21
    v_dot2_f32_bf16 v23, v37, v37, v23
    v_dot2_f32_bf16 v21, v38, v18, v21
    v_dot2_f32_bf16 v23, v38, v38, v23
    v_dot2_f32_bf16 v21, v39, v18, v21
    v_dot2_f32_bf16 v23, v39, v39, v23
K1H_S2_0a:
    s_cmp_lg_u32 s52, 0
    s_cbranch_scc1 K1H_S2_0b
    v_dot2_f32_bf16 v24, v40, v18, v24
    v_dot2_f32_bf16 v24, v41, v18, v24
    v_dot2_f32_bf16 v24, v42, v18, v24
    v_dot2_f32_bf16 v24, v43, v18, v24
K1H_S2_0b:
    s_cmp_eq_u32 s54, 0
    s_cbranch_scc1 K1H_S2_0c
    v_dot2_f32_bf16 v25, v32, v160, v25
    v_dot2_f32_bf16 v25, v33, v161, v25
    v_dot2_f32_bf16 v25, v34, v162, v25
    v_dot2_f32_bf16 v25, v35, v163, v25
    v_dot2_f32_bf16 v26, v36, v160, v26
    v_dot2_f32_bf16 v26, v37, v161, v26
    v_dot2_f32_bf16 v26, v38, v162, v26
    v_dot2_f32_bf16 v26, v39, v163, v26
K1H_S2_0c:
    s_setprio 1
    ds_read_b128 v[32:35], v12 offset:1024
    ds_read_b128 v[36:39], v12 offset:5120
    ds_read_b64_tr_b16 v[40:41], v15 offset:24576
    ds_read_b64_tr_b16 v[42:43], v15 offset:25600
    s_waitcnt lgkmcnt(4)
    v_mfma_f32_32x32x16_bf16 v[64:79], v[52:55], v[44:47], v[64:79]
    v_mfma_f32_32x32x16_bf16 v[80:95], v[52:55], v[48:51], v[80:95]
    s_cmp_lg_u32 s53, 1
    s_cbranch_scc1 K1H_S2_1a
    v_dot2_f32_bf16 v20, v44, v18, v20
    v_dot2_f32_bf16 v22, v44, v44, v22
    v_dot2_f32_bf16 v20, v45, v18, v20
    v_dot2_f32_bf16 v22, v45, v45, v22
    v_dot2_f32_bf16 v20, v46, v18, v20
    v_dot2_f32_bf16 v22, v46, v46, v22
    v_dot2_f32_bf16 v20, v47, v18, v20
    v_dot2_f32_bf16 v22, v47, v47, v22
    v_dot2_f32_bf16 v21, v48, v18, v21
    v_dot2_f32_bf16 v23, v48, v48, v23
    v_dot2_f32_bf16 v21, v49, v18, v21
    v_dot2_f32_bf16 v23, v49, v49, v23
    v_dot2_f32_bf16 v21, v50, v18, v21
    v_dot2_f32_bf16 v23, v50, v50, v23
    v_dot2_f32_bf16 v21, v51, v18, v21
    v_dot2_f32_bf16 v23, v51, v51, v23
K1H_S2_1a:
    s_cmp_lg_u32 s52, 1
    s_cbranch_scc1 K1H_S2_1b
    v_dot2_f32_bf16 v24, v52, v18, v24
    v_dot2_f32_bf16 v24, v53, v18, v24
    v_dot2_f32_bf16 v24, v54, v18, v24
    v_dot2_f32_bf16 v24, v55, v18, v24
K1H_S2_1b:
    s_cmp_eq_u32 s54, 0
    s_cbranch_scc1 K1H_S2_1c
    v_dot2_f32_bf16 v25, v44, v164, v25
    v_dot2_f32_bf16 v25, v45, v165, v25
    v_dot2_f32_bf16 v25, v46, v166, v25
    v_dot2_f32_bf16 v25, v47, v167, v25
    v_dot2_f32_bf16 v26, v48, v164, v26
    v_dot2_f32_bf16 v26, v49, v165, v26
    v_dot2_f32_bf16 v26, v50, v166, v26
    v_dot2_f32_bf16 v26, v51, v167, v26
K1H_S2_1c:
    s_setprio 0
    ds_read_b128 v[44:47], v13 offset:1024
    ds_read_b128 v[48:51], v13 offset:5120
    ds_read_b64_tr_b16 v[52:53], v15 offset:28672
    ds_read_b64_tr_b16 v[54:55], v15 offset:29696
    s_waitcnt lgkmcnt(4)
    v_mfma_f32_32x32x16_bf16 v[64:79], v[40:43], v[32:35], v[64:79]
    v_mfma_f32_32x32x16_bf16 v[80:95], v[40:43], v[36:39], v[80:95]
    s_cmp_lg_u32 s53, 2
    s_cbranch_scc1 K1H_S2_2a
    v_dot2_f32_bf16 v20, v32, v18, v20
    v_dot2_f32_bf16 v22, v32, v32, v22
    v_dot2_f32_bf16 v20, v33, v18, v20
    v_dot2_f32_bf16 v22, v33, v33, v22
    v_dot2_f32_bf16 v20, v34, v18, v20
    v_dot2_f32_bf16 v22, v34, v34, v22
    v_dot2_f32_bf16 v20, v35, v18, v20
    v_dot2_f32_bf16 v22, v35, v35, v22
    v_dot2_f32_bf16 v21, v36, v18, v21
    v_dot2_f32_bf16 v23, v36, v36, v23
    v_dot2_f32_bf16 v21, v37, v18, v21
    v_dot2_f32_bf16 v23, v37, v37, v23
    v_dot2_f32_bf16 v21, v38, v18, v21
    v_dot2_f32_bf16 v23, v38, v38, v23
    v_dot2_f32_bf16 v21, v39, v18, v21
    v_dot2_f32_bf16 v23, v39, v39, v23
K1H_S2_2a:
    s_cmp_lg_u32 s52, 0
    s_cbranch_scc1 K1H_S2_2b
    v_dot2_f32_bf16 v24, v40, v18, v24
    v_dot2_f32_bf16 v24, v41, v18, v24
    v_dot2_f32_bf16 v24, v42, v18, v24
    v_dot2_f32_bf16 v24, v43, v18, v24
K1H_S2_2b:
    s_cmp_eq_u32 s54, 0
    s_cbranch_scc1 K1H_S2_2c
    v_dot2_f32_bf16 v25, v32, v168, v25
    v_dot2_f32_bf16 v25, v33, v169, v25
    v_dot2_f32_bf16 v25, v34, v170, v25
    v_dot2_f32_bf16 v25, v35, v171, v25
    v_dot2_f32_bf16 v26, v36, v168, v26
    v_dot2_f32_bf16 v26, v37, v169, v26
    v_dot2_f32_bf16 v26, v38, v170, v26
    v_dot2_f32_bf16 v26, v39, v171, v26
K1H_S2_2c:
    s_waitcnt vmcnt(4)
    s_barrier
    s_setprio 3
    s_mov_b32 s30, 640
    s_mul_i32 s31, s33, 5
    s_add_u32 m0, s32, 32768
    s_nop 0
    buffer_load_dwordx4 v2, s[12:15], s30 offen lds
    s_add_u32 m0, s32, 33792
    s_nop 0
    buffer_load_dwordx4 v3, s[12:15], s30 offen lds
    s_add_u32 m0, s32, 49152
    s_nop 0
    buffer_load_dwordx4 v6, s[16:19], s31 offen lds
    s_add_u32 m0, s32, 50176
    s_nop 0
    buffer_load_dwordx4 v7, s[16:19], s31 offen lds
    ds_read_b128 v[32:35], v12 offset:32768
    ds_read_b128 v[36:39], v12 offset:36864
    ds_read_b64_tr_b16 v[40:41], v15 offset:49152
    ds_read_b64_tr_b16 v[42:43], v15 offset:50176
    s_waitcnt lgkmcnt(4)
    v_mfma_f32_32x32x16_bf16 v[64:79], v[52:55], v[44:47], v[64:79]
    v_mfma_f32_32x32x16_bf16 v[80:95], v[52:55], v[48:51], v[80:95]
    s_cmp_lg_u32 s53, 3
    s_cbranch_scc1 K1H_S2_3a
    v_dot2_f32_bf16 v20, v44, v18, v20
    v_dot2_f32_bf16 v22, v44, v44, v22
    v_dot2_f32_bf16 v20, v45, v18, v20
    v_dot2_f32_bf16 v22, v45, v45, v22
    v_dot2_f32_bf16 v20, v46, v18, v20
    v_dot2_f32_bf16 v22, v46, v46, v22
    v_dot2_f32_bf16 v20, v47, v18, v20
    v_dot2_f32_bf16 v22, v47, v47, v22
    v_dot2_f32_bf16 v21, v48, v18, v21
    v_dot2_f32_bf16 v23, v48, v48, v23
    v_dot2_f32_bf16 v21, v49, v18, v21
    v_dot2_f32_bf16 v23, v49, v49, v23
    v_dot2_f32_bf16 v21, v50, v18, v21
    v_dot2_f32_bf16 v23, v50, v50, v23
    v_dot2_f32_bf16 v21, v51, v18, v21
    v_dot2_f32_bf16 v23, v51, v51, v23
K1H_S2_3a:
    s_cmp_lg_u32 s52, 1
    s_cbranch_scc1 K1H_S2_3b
    v_dot2_f32_bf16 v24, v52, v18, v24
    v_dot2_f32_bf16 v24, v53, v18, v24
    v_dot2_f32_bf16 v24, v54, v18, v24
    v_dot2_f32_bf16 v24, v55, v18, v24
K1H_S2_3b:
    s_cmp_eq_u32 s54, 0
    s_cbranch_scc1 K1H_S2_3c
    v_dot2_f32_bf16 v25, v44, v172, v25
    v_dot2_f32_bf16 v25, v45, v173, v25
    v_dot2_f32_bf16 v25, v46, v174, v25
    v_dot2_f32_bf16 v25, v47, v175, v25
    v_dot2_f32_bf16 v26, v48, v172, v26
    v_dot2_f32_bf16 v26, v49, v173, v26
    v_dot2_f32_bf16 v26, v50, v174, v26
    v_dot2_f32_bf16 v26, v51, v175, v26
K1H_S2_3c:
    s_setprio 2
    ds_read_b128 v[44:47], v13 offset:32768
    ds_read_b128 v[48:51], v13 offset:36864
    ds_read_b64_tr_b16 v[52:53], v15 offset:53248
    ds_read_b64_tr_b16 v[54:55], v15 offset:54272
    s_waitcnt lgkmcnt(4)
    v_mfma_f32_32x32x16_bf16 v[64:79], v[40:43], v[32:35], v[64:79]
    v_mfma_f32_32x32x16_bf16 v[80:95], v[40:43], v[36:39], v[80:95]
    s_cmp_lg_u32 s53, 0
    s_cbranch_scc1 K1H_S3_0a
    v_dot2_f32_bf16 v20, v32, v18, v20
    v_dot2_f32_bf16 v22, v32, v32, v22
    v_dot2_f32_bf16 v20, v33, v18, v20
    v_dot2_f32_bf16 v22, v33, v33, v22
    v_dot2_f32_bf16 v20, v34, v18, v20
    v_dot2_f32_bf16 v22, v34, v34, v22
    v_dot2_f32_bf16 v20, v35, v18, v20
    v_dot2_f32_bf16 v22, v35, v35, v22
    v_dot2_f32_bf16 v21, v36, v18, v21
    v_dot2_f32_bf16 v23, v36, v36, v23
    v_dot2_f32_bf16 v21, v37, v18, v21
    v_dot2_f32_bf16 v23, v37, v37, v23
    v_dot2_f32_bf16 v21, v38, v18, v21
    v_dot2_f32_bf16 v23, v38, v38, v23
    v_dot2_f32_bf16 v21, v39, v18, v21
    v_dot2_f32_bf16 v23, v39, v39, v23
K1H_S3_0a:
    s_cmp_lg_u32 s52, 0
    s_cbranch_scc1 K1H_S3_0b
    v_dot2_f32_bf16 v24, v40, v18, v24
    v_dot2_f32_bf16 v24, v41, v18, v24
    v_dot2_f32_bf16 v24, v42, v18, v24
    v_dot2_f32_bf16 v24, v43, v18, v24
K1H_S3_0b:
    s_cmp_eq_u32 s54, 0
    s_cbranch_scc1 K1H_S3_0c
    v_dot2_f32_bf16 v25, v32, v176, v25
    v_dot2_f32_bf16 v25, v33, v177, v25
    v_dot2_f32_bf16 v25, v34, v178, v25
    v_dot2_f32_bf16 v25, v35, v179, v25
    v_dot2_f32_bf16 v26, v36, v176, v26
    v_dot2_f32_bf16 v26, v37, v177, v26
    v_dot2_f32_bf16 v26, v38, v178, v26
    v_dot2_f32_bf16 v26, v39, v179, v26
K1H_S3_0c:
    s_setprio 1
    ds_read_b128 v[32:35], v12 offset:33792
    ds_read_b128 v[36:39], v12 offset:37888
    ds_read_b64_tr_b16 v[40:41], v15 offset:57344
    ds_read_b64_tr_b16 v[42:43], v15 offset:58368
    s_waitcnt lgkmcnt(4)
    v_mfma_f32_32x32x16_bf16 v[64:79], v[52:55], v[44:47], v[64:79]
    v_mfma_f32_32x32x16_bf16 v[80:95], v[52:55], v[48:51], v[80:95]
    s_cmp_lg_u32 s53, 1
    s_cbranch_scc1 K1H_S3_1a
    v_dot2_f32_bf16 v20, v44, v18, v20
    v_dot2_f32_bf16 v22, v44, v44, v22
    v_dot2_f32_bf16 v20, v45, v18, v20
    v_dot2_f32_bf16 v22, v45, v45, v22
    v_dot2_f32_bf16 v20, v46, v18, v20
    v_dot2_f32_bf16 v22, v46, v46, v22
    v_dot2_f32_bf16 v20, v47, v18, v20
    v_dot2_f32_bf16 v22, v47, v47, v22
    v_dot2_f32_bf16 v21, v48, v18, v21
    v_dot2_f32_bf16 v23, v48, v48, v23
    v_dot2_f32_bf16 v21, v49, v18, v21
    v_dot2_f32_bf16 v23, v49, v49, v23
    v_dot2_f32_bf16 v21, v50, v18, v21
    v_dot2_f32_bf16 v23, v50, v50, v23
    v_dot2_f32_bf16 v21, v51, v18, v21
    v_dot2_f32_bf16 v23, v51, v51, v23
K1H_S3_1a:
    s_cmp_lg_u32 s52, 1
    s_cbranch_scc1 K1H_S3_1b
    v_dot2_f32_bf16 v24, v52, v18, v24
    v_dot2_f32_bf16 v24, v53, v18, v24
    v_dot2_f32_bf16 v24, v54, v18, v24
    v_dot2_f32_bf16 v24, v55, v18, v24
K1H_S3_1b:
    s_cmp_eq_u32 s54, 0
    s_cbranch_scc1 K1H_S3_1c
    v_dot2_f32_bf16 v25, v44, v180, v25
    v_dot2_f32_bf16 v25, v45, v181, v25
    v_dot2_f32_bf16 v25, v46, v182, v25
    v_dot2_f32_bf16 v25, v47, v183, v25
    v_dot2_f32_bf16 v26, v48, v180, v26
    v_dot2_f32_bf16 v26, v49, v181, v26
    v_dot2_f32_bf16 v26, v50, v182, v26
    v_dot2_f32_bf16 v26, v51, v183, v26
K1H_S3_1c:
    s_setprio 0
    ds_read_b128 v[44:47], v13 offset:33792
    ds_read_b128 v[48:51], v13 offset:37888
    ds_read_b64_tr_b16 v[52:53], v15 offset:61440
    ds_read_b64_tr_b16 v[54:55], v15 offset:62464
    s_waitcnt lgkmcnt(4)
    v_mfma_f32_32x32x16_bf16 v[64:79], v[40:43], v[32:35], v[64:79]
    v_mfma_f32_32x32x16_bf16 v[80:95], v[40:43], v[36:39], v[80:95]
    s_cmp_lg_u32 s53, 2
    s_cbranch_scc1 K1H_S3_2a
    v_dot2_f32_bf16 v20, v32, v18, v20
    v_dot2_f32_bf16 v22, v32, v32, v22
    v_dot2_f32_bf16 v20, v33, v18, v20
    v_dot2_f32_bf16 v22, v33, v33, v22
    v_dot2_f32_bf16 v20, v34, v18, v20
    v_dot2_f32_bf16 v22, v34, v34, v22
    v_dot2_f32_bf16 v20, v35, v18, v20
    v_dot2_f32_bf16 v22, v35, v35, v22
    v_dot2_f32_bf16 v21, v36, v18, v21
    v_dot2_f32_bf16 v23, v36, v36, v23
    v_dot2_f32_bf16 v21, v37, v18, v21
    v_dot2_f32_bf16 v23, v37, v37, v23
    v_dot2_f32_bf16 v21, v38, v18, v21
    v_dot2_f32_bf16 v23, v38, v38, v23
    v_dot2_f32_bf16 v21, v39, v18, v21
    v_dot2_f32_bf16 v23, v39, v39, v23
K1H_S3_2a:
    s_cmp_lg_u32 s52, 0
    s_cbranch_scc1 K1H_S3_2b
    v_dot2_f32_bf16 v24, v40, v18, v24
    v_dot2_f32_bf16 v24, v41, v18, v24
    v_dot2_f32_bf16 v24, v42, v18, v24
    v_dot2_f32_bf16 v24, v43, v18, v24
K1H_S3_2b:
    s_cmp_eq_u32 s54, 0
    s_cbranch_scc1 K1H_S3_2c
    v_dot2_f32_bf16 v25, v32, v184, v25
    v_dot2_f32_bf16 v25, v33, v185, v25
    v_dot2_f32_bf16 v25, v34, v186, v25
    v_dot2_f32_bf16 v25, v35, v187, v25
    v_dot2_f32_bf16 v26, v36, v184, v26
    v_dot2_f32_bf16 v26, v37, v185, v26
    v_dot2_f32_bf16 v26, v38, v186, v26
    v_dot2_f32_bf16 v26, v39, v187, v26
K1H_S3_2c:
    s_waitcnt vmcnt(4)
    s_barrier
    s_setprio 3
    s_mov_b32 s30, 768
    s_mul_i32 s31, s33, 6
    s_add_u32 m0, s32, 65536
    s_nop 0
    buffer_load_dwordx4 v2, s[12:15], s30 offen lds
    s_add_u32 m0, s32, 66560
    s_nop 0
    buffer_load_dwordx4 v3, s[12:15], s30 offen lds
    s_add_u32 m0, s32, 81920
    s_nop 0
    buffer_load_dwordx4 v6, s[16:19], s31 offen lds
    s_add_u32 m0, s32, 82944
    s_nop 0
    buffer_load_dwordx4 v7, s[16:19], s31 offen lds
    ds_read_b128 v[32:35], v10 offset:0
    ds_read_b128 v[36:39], v10 offset:4096
    ds_read_b64_tr_b16 v[40:41], v14 offset:16384
    ds_read_b64_tr_b16 v[42:43], v14 offset:17408
    s_waitcnt lgkmcnt(4)
    v_mfma_f32_32x32x16_bf16 v[64:79], v[52:55], v[44:47], v[64:79]
    v_mfma_f32_32x32x16_bf16 v[80:95], v[52:55], v[48:51], v[80:95]
    s_cmp_lg_u32 s53, 3
    s_cbranch_scc1 K1H_S3_3a
    v_dot2_f32_bf16 v20, v44, v18, v20
    v_dot2_f32_bf16 v22, v44, v44, v22
    v_dot2_f32_bf16 v20, v45, v18, v20
    v_dot2_f32_bf16 v22, v45, v45, v22
    v_dot2_f32_bf16 v20, v46, v18, v20
    v_dot2_f32_bf16 v22, v46, v46, v22
    v_dot2_f32_bf16 v20, v47, v18, v20
    v_dot2_f32_bf16 v22, v47, v47, v22
    v_dot2_f32_bf16 v21, v48, v18, v21
    v_dot2_f32_bf16 v23, v48, v48, v23
    v_dot2_f32_bf16 v21, v49, v18, v21
    v_dot2_f32_bf16 v23, v49, v49, v23
    v_dot2_f32_bf16 v21, v50, v18, v21
    v_dot2_f32_bf16 v23, v50, v50, v23
    v_dot2_f32_bf16 v21, v51, v18, v21
    v_dot2_f32_bf16 v23, v51, v51, v23
K1H_S3_3a:
    s_cmp_lg_u32 s52, 1
    s_cbranch_scc1 K1H_S3_3b
    v_dot2_f32_bf16 v24, v52, v18, v24
    v_dot2_f32_bf16 v24, v53, v18, v24
    v_dot2_f32_bf16 v24, v54, v18, v24
    v_dot2_f32_bf16 v24, v55, v18, v24
K1H_S3_3b:
    s_cmp_eq_u32 s54, 0
    s_cbranch_scc1 K1H_S3_3c
    v_dot2_f32_bf16 v25, v44, v188, v25
    v_dot2_f32_bf16 v25, v45, v189, v25
    v_dot2_f32_bf16 v25, v46, v190, v25
    v_dot2_f32_bf16 v25, v47, v191, v25
    v_dot2_f32_bf16 v26, v48, v188, v26
    v_dot2_f32_bf16 v26, v49, v189, v26
    v_dot2_f32_bf16 v26, v50, v190, v26
    v_dot2_f32_bf16 v26, v51, v191, v26
K1H_S3_3c:
    s_setprio 2
    ds_read_b128 v[44:47], v11 offset:0
    ds_read_b128 v[48:51], v11 offset:4096
    ds_read_b64_tr_b16 v[52:53], v14 offset:20480
    ds_read_b64_tr_b16 v[54:55], v14 offset:21504
    s_waitcnt lgkmcnt(4)
    v_mfma_f32_32x32x16_bf16 v[64:79], v[40:43], v[32:35], v[64:79]
    v_mfma_f32_32x32x16_bf16 v[80:95], v[40:43], v[36:39], v[80:95]
    s_cmp_lg_u32 s53, 0
    s_cbranch_scc1 K1H_S4_0a
    v_dot2_f32_bf16 v20, v32, v18, v20
    v_dot2_f32_bf16 v22, v32, v32, v22
    v_dot2_f32_bf16 v20, v33, v18, v20
    v_dot2_f32_bf16 v22, v33, v33, v22
    v_dot2_f32_bf16 v20, v34, v18, v20
    v_dot2_f32_bf16 v22, v34, v34, v22
    v_dot2_f32_bf16 v20, v35, v18, v20
    v_dot2_f32_bf16 v22, v35, v35, v22
    v_dot2_f32_bf16 v21, v36, v18, v21
    v_dot2_f32_bf16 v23, v36, v36, v23
    v_dot2_f32_bf16 v21, v37, v18, v21
    v_dot2_f32_bf16 v23, v37, v37, v23
    v_dot2_f32_bf16 v21, v38, v18, v21
    v_dot2_f32_bf16 v23, v38, v38, v23
    v_dot2_f32_bf16 v21, v39, v18, v21
    v_dot2_f32_bf16 v23, v39, v39, v23
K1H_S4_0a:
    s_cmp_lg_u32 s52, 0
    s_cbranch_scc1 K1H_S4_0b
    v_dot2_f32_bf16 v24, v40, v18, v24
    v_dot2_f32_bf16 v24, v41, v18, v24
    v_dot2_f32_bf16 v24, v42, v18, v24
    v_dot2_f32_bf16 v24, v43, v18, v24
K1H_S4_0b:
    s_cmp_eq_u32 s54, 0
    s_cbranch_scc1 K1H_S4_0c
    v_dot2_f32_bf16 v25, v32, v192, v25
    v_dot2_f32_bf16 v25, v33, v193, v25
    v_dot2_f32_bf16 v25, v34, v194, v25
    v_dot2_f32_bf16 v25, v35, v195, v25
    v_dot2_f32_bf16 v26, v36, v192, v26
    v_dot2_f32_bf16 v26, v37, v193, v26
    v_dot2_f32_bf16 v26, v38, v194, v26
    v_dot2_f32_bf16 v26, v39, v195, v26
K1H_S4_0c:
    s_setprio 1
    ds_read_b128 v[32:35], v10 offset:1024
    ds_read_b128 v[36:39], v10 offset:5120
    ds_read_b64_tr_b16 v[40:41], v14 offset:24576
    ds_read_b64_tr_b16 v[42:43], v14 offset:25600
    s_waitcnt lgkmcnt(4)
    v_mfma_f32_32x32x16_bf16 v[64:79], v[52:55], v[44:47], v[64:79]
    v_mfma_f32_32x32x16_bf16 v[80:95], v[52:55], v[48:51], v[80:95]
    s_cmp_lg_u32 s53, 1
    s_cbranch_scc1 K1H_S4_1a
    v_dot2_f32_bf16 v20, v44, v18, v20
    v_dot2_f32_bf16 v22, v44, v44, v22
    v_dot2_f32_bf16 v20, v45, v18, v20
    v_dot2_f32_bf16 v22, v45, v45, v22
    v_dot2_f32_bf16 v20, v46, v18, v20
    v_dot2_f32_bf16 v22, v46, v46, v22
    v_dot2_f32_bf16 v20, v47, v18, v20
    v_dot2_f32_bf16 v22, v47, v47, v22
    v_dot2_f32_bf16 v21, v48, v18, v21
    v_dot2_f32_bf16 v23, v48, v48, v23
    v_dot2_f32_bf16 v21, v49, v18, v21
    v_dot2_f32_bf16 v23, v49, v49, v23
    v_dot2_f32_bf16 v21, v50, v18, v21
    v_dot2_f32_bf16 v23, v50, v50, v23
    v_dot2_f32_bf16 v21, v51, v18, v21
    v_dot2_f32_bf16 v23, v51, v51, v23
K1H_S4_1a:
    s_cmp_lg_u32 s52, 1
    s_cbranch_scc1 K1H_S4_1b
    v_dot2_f32_bf16 v24, v52, v18, v24
    v_dot2_f32_bf16 v24, v53, v18, v24
    v_dot2_f32_bf16 v24, v54, v18, v24
    v_dot2_f32_bf16 v24, v55, v18, v24
K1H_S4_1b:
    s_cmp_eq_u32 s54, 0
    s_cbranch_scc1 K1H_S4_1c
    v_dot2_f32_bf16 v25, v44, v196, v25
    v_dot2_f32_bf16 v25, v45, v197, v25
    v_dot2_f32_bf16 v25, v46, v198, v25
    v_dot2_f32_bf16 v25, v47, v199, v25
    v_dot2_f32_bf16 v26, v48, v196, v26
    v_dot2_f32_bf16 v26, v49, v197, v26
    v_dot2_f32_bf16 v26, v50, v198, v26
    v_dot2_f32_bf16 v26, v51, v199, v26
K1H_S4_1c:
    s_setprio 0
    ds_read_b128 v[44:47], v11 offset:1024
    ds_read_b128 v[48:51], v11 offset:5120
    ds_read_b64_tr_b16 v[52:53], v14 offset:28672
    ds_read_b64_tr_b16 v[54:55], v14 offset:29696
    s_waitcnt lgkmcnt(4)
    v_mfma_f32_32x32x16_bf16 v[64:79], v[40:43], v[32:35], v[64:79]
    v_mfma_f32_32x32x16_bf16 v[80:95], v[40:43], v[36:39], v[80:95]
    s_cmp_lg_u32 s53, 2
    s_cbranch_scc1 K1H_S4_2a
    v_dot2_f32_bf16 v20, v32, v18, v20
    v_dot2_f32_bf16 v22, v32, v32, v22
    v_dot2_f32_bf16 v20, v33, v18, v20
    v_dot2_f32_bf16 v22, v33, v33, v22
    v_dot2_f32_bf16 v20, v34, v18, v20
    v_dot2_f32_bf16 v22, v34, v34, v22
    v_dot2_f32_bf16 v20, v35, v18, v20
    v_dot2_f32_bf16 v22, v35, v35, v22
    v_dot2_f32_bf16 v21, v36, v18, v21
    v_dot2_f32_bf16 v23, v36, v36, v23
    v_dot2_f32_bf16 v21, v37, v18, v21
    v_dot2_f32_bf16 v23, v37, v37, v23
    v_dot2_f32_bf16 v21, v38, v18, v21
    v_dot2_f32_bf16 v23, v38, v38, v23
    v_dot2_f32_bf16 v21, v39, v18, v21
    v_dot2_f32_bf16 v23, v39, v39, v23
K1H_S4_2a:
    s_cmp_lg_u32 s52, 0
    s_cbranch_scc1 K1H_S4_2b
    v_dot2_f32_bf16 v24, v40, v18, v24
    v_dot2_f32_bf16 v24, v41, v18, v24
    v_dot2_f32_bf16 v24, v42, v18, v24
    v_dot2_f32_bf16 v24, v43, v18, v24
K1H_S4_2b:
    s_cmp_eq_u32 s54, 0
    s_cbranch_scc1 K1H_S4_2c
    v_dot2_f32_bf16 v25, v32, v200, v25
    v_dot2_f32_bf16 v25, v33, v201, v25
    v_dot2_f32_bf16 v25, v34, v202, v25
    v_dot2_f32_bf16 v25, v35, v203, v25
    v_dot2_f32_bf16 v26, v36, v200, v26
    v_dot2_f32_bf16 v26, v37, v201, v26
    v_dot2_f32_bf16 v26, v38, v202, v26
    v_dot2_f32_bf16 v26, v39, v203, v26
K1H_S4_2c:
    s_waitcnt vmcnt(4)
    s_barrier
    s_setprio 3
    ds_read_b128 v[32:35], v10 offset:32768
    ds_read_b128 v[36:39], v10 offset:36864
    ds_read_b64_tr_b16 v[40:41], v14 offset:49152
    ds_read_b64_tr_b16 v[42:43], v14 offset:50176
    s_waitcnt lgkmcnt(4)
    v_mfma_f32_32x32x16_bf16 v[64:79], v[52:55], v[44:47], v[64:79]
    v_mfma_f32_32x32x16_bf16 v[80:95], v[52:55], v[48:51], v[80:95]
    s_cmp_lg_u32 s53, 3
    s_cbranch_scc1 K1H_S4_3a
    v_dot2_f32_bf16 v20, v44, v18, v20
    v_dot2_f32_bf16 v22, v44, v44, v22
    v_dot2_f32_bf16 v20, v45, v18, v20
    v_dot2_f32_bf16 v22, v45, v45, v22
    v_dot2_f32_bf16 v20, v46, v18, v20
    v_dot2_f32_bf16 v22, v46, v46, v22
    v_dot2_f32_bf16 v20, v47, v18, v20
    v_dot2_f32_bf16 v22, v47, v47, v22
    v_dot2_f32_bf16 v21, v48, v18, v21
    v_dot2_f32_bf16 v23, v48, v48, v23
    v_dot2_f32_bf16 v21, v49, v18, v21
    v_dot2_f32_bf16 v23, v49, v49, v23
    v_dot2_f32_bf16 v21, v50, v18, v21
    v_dot2_f32_bf16 v23, v50, v50, v23
    v_dot2_f32_bf16 v21, v51, v18, v21
    v_dot2_f32_bf16 v23, v51, v51, v23
K1H_S4_3a:
    s_cmp_lg_u32 s52, 1
    s_cbranch_scc1 K1H_S4_3b
    v_dot2_f32_bf16 v24, v52, v18, v24
    v_dot2_f32_bf16 v24, v53, v18, v24
    v_dot2_f32_bf16 v24, v54, v18, v24
    v_dot2_f32_bf16 v24, v55, v18, v24
K1H_S4_3b:
    s_cmp_eq_u32 s54, 0
    s_cbranch_scc1 K1H_S4_3c
    v_dot2_f32_bf16 v25, v44, v204, v25
    v_dot2_f32_bf16 v25, v45, v205, v25
    v_dot2_f32_bf16 v25, v46, v206, v25
    v_dot2_f32_bf16 v25, v47, v207, v25
    v_dot2_f32_bf16 v26, v48, v204, v26
    v_dot2_f32_bf16 v26, v49, v205, v26
    v_dot2_f32_bf16 v26, v50, v206, v26
    v_dot2_f32_bf16 v26, v51, v207, v26
K1H_S4_3c:
    s_setprio 2
    ds_read_b128 v[44:47], v11 offset:32768
    ds_read_b128 v[48:51], v11 offset:36864
    ds_read_b64_tr_b16 v[52:53], v14 offset:53248
    ds_read_b64_tr_b16 v[54:55], v14 offset:54272
    s_waitcnt lgkmcnt(4)
    v_mfma_f32_32x32x16_bf16 v[64:79], v[40:43], v[32:35], v[64:79]
    v_mfma_f32_32x32x16_bf16 v[80:95], v[40:43], v[36:39], v[80:95]
    s_cmp_lg_u32 s53, 0
    s_cbranch_scc1 K1H_S5_0a
    v_dot2_f32_bf16 v20, v32, v18, v20
    v_dot2_f32_bf16 v22, v32, v32, v22
    v_dot2_f32_bf16 v20, v33, v18, v20
    v_dot2_f32_bf16 v22, v33, v33, v22
    v_dot2_f32_bf16 v20, v34, v18, v20
    v_dot2_f32_bf16 v22, v34, v34, v22
    v_dot2_f32_bf16 v20, v35, v18, v20
    v_dot2_f32_bf16 v22, v35, v35, v22
    v_dot2_f32_bf16 v21, v36, v18, v21
    v_dot2_f32_bf16 v23, v36, v36, v23
    v_dot2_f32_bf16 v21, v37, v18, v21
    v_dot2_f32_bf16 v23, v37, v37, v23
    v_dot2_f32_bf16 v21, v38, v18, v21
    v_dot2_f32_bf16 v23, v38, v38, v23
    v_dot2_f32_bf16 v21, v39, v18, v21
    v_dot2_f32_bf16 v23, v39, v39, v23
K1H_S5_0a:
    s_cmp_lg_u32 s52, 0
    s_cbranch_scc1 K1H_S5_0b
    v_dot2_f32_bf16 v24, v40, v18, v24
    v_dot2_f32_bf16 v24, v41, v18, v24
    v_dot2_f32_bf16 v24, v42, v18, v24
    v_dot2_f32_bf16 v24, v43, v18, v24
K1H_S5_0b:
    s_cmp_eq_u32 s54, 0
    s_cbranch_scc1 K1H_S5_0c
    v_dot2_f32_bf16 v25, v32, v208, v25
    v_dot2_f32_bf16 v25, v33, v209, v25
    v_dot2_f32_bf16 v25, v34, v210, v25
    v_dot2_f32_bf16 v25, v35, v211, v25
    v_dot2_f32_bf16 v26, v36, v208, v26
    v_dot2_f32_bf16 v26, v37, v209, v26
    v_dot2_f32_bf16 v26, v38, v210, v26
    v_dot2_f32_bf16 v26, v39, v211, v26
K1H_S5_0c:
    s_setprio 1
    ds_read_b128 v[32:35], v10 offset:33792
    ds_read_b128 v[36:39], v10 offset:37888
    ds_read_b64_tr_b16 v[40:41], v14 offset:57344
    ds_read_b64_tr_b16 v[42:43], v14 offset:58368
    s_waitcnt lgkmcnt(4)
    v_mfma_f32_32x32x16_bf16 v[64:79], v[52:55], v[44:47], v[64:79]
    v_mfma_f32_32x32x16_bf16 v[80:95], v[52:55], v[48:51], v[80:95]
    s_cmp_lg_u32 s53, 1
    s_cbranch_scc1 K1H_S5_1a
    v_dot2_f32_bf16 v20, v44, v18, v20
    v_dot2_f32_bf16 v22, v44, v44, v22
    v_dot2_f32_bf16 v20, v45, v18, v20
    v_dot2_f32_bf16 v22, v45, v45, v22
    v_dot2_f32_bf16 v20, v46, v18, v20
    v_dot2_f32_bf16 v22, v46, v46, v22
    v_dot2_f32_bf16 v20, v47, v18, v20
    v_dot2_f32_bf16 v22, v47, v47, v22
    v_dot2_f32_bf16 v21, v48, v18, v21
    v_dot2_f32_bf16 v23, v48, v48, v23
    v_dot2_f32_bf16 v21, v49, v18, v21
    v_dot2_f32_bf16 v23, v49, v49, v23
    v_dot2_f32_bf16 v21, v50, v18, v21
    v_dot2_f32_bf16 v23, v50, v50, v23
    v_dot2_f32_bf16 v21, v51, v18, v21
    v_dot2_f32_bf16 v23, v51, v51, v23
K1H_S5_1a:
    s_cmp_lg_u32 s52, 1
    s_cbranch_scc1 K1H_S5_1b
    v_dot2_f32_bf16 v24, v52, v18, v24
    v_dot2_f32_bf16 v24, v53, v18, v24
    v_dot2_f32_bf16 v24, v54, v18, v24
    v_dot2_f32_bf16 v24, v55, v18, v24
K1H_S5_1b:
    s_cmp_eq_u32 s54, 0
    s_cbranch_scc1 K1H_S5_1c
    v_dot2_f32_bf16 v25, v44, v212, v25
    v_dot2_f32_bf16 v25, v45, v213, v25
    v_dot2_f32_bf16 v25, v46, v214, v25
    v_dot2_f32_bf16 v25, v47, v215, v25
    v_dot2_f32_bf16 v26, v48, v212, v26
    v_dot2_f32_bf16 v26, v49, v213, v26
    v_dot2_f32_bf16 v26, v50, v214, v26
    v_dot2_f32_bf16 v26, v51, v215, v26
K1H_S5_1c:
    s_setprio 0
    ds_read_b128 v[44:47], v11 offset:33792
    ds_read_b128 v[48:51], v11 offset:37888
    ds_read_b64_tr_b16 v[52:53], v14 offset:61440
    ds_read_b64_tr_b16 v[54:55], v14 offset:62464
    s_waitcnt lgkmcnt(4)
    v_mfma_f32_32x32x16_bf16 v[64:79], v[40:43], v[32:35], v[64:79]
    v_mfma_f32_32x32x16_bf16 v[80:95], v[40:43], v[36:39], v[80:95]
    s_cmp_lg_u32 s53, 2
    s_cbranch_scc1 K1H_S5_2a
    v_dot2_f32_bf16 v20, v32, v18, v20
    v_dot2_f32_bf16 v22, v32, v32, v22
    v_dot2_f32_bf16 v20, v33, v18, v20
    v_dot2_f32_bf16 v22, v33, v33, v22
    v_dot2_f32_bf16 v20, v34, v18, v20
    v_dot2_f32_bf16 v22, v34, v34, v22
    v_dot2_f32_bf16 v20, v35, v18, v20
    v_dot2_f32_bf16 v22, v35, v35, v22
    v_dot2_f32_bf16 v21, v36, v18, v21
    v_dot2_f32_bf16 v23, v36, v36, v23
    v_dot2_f32_bf16 v21, v37, v18, v21
    v_dot2_f32_bf16 v23, v37, v37, v23
    v_dot2_f32_bf16 v21, v38, v18, v21
    v_dot2_f32_bf16 v23, v38, v38, v23
    v_dot2_f32_bf16 v21, v39, v18, v21
    v_dot2_f32_bf16 v23, v39, v39, v23
K1H_S5_2a:
    s_cmp_lg_u32 s52, 0
    s_cbranch_scc1 K1H_S5_2b
    v_dot2_f32_bf16 v24, v40, v18, v24
    v_dot2_f32_bf16 v24, v41, v18, v24
    v_dot2_f32_bf16 v24, v42, v18, v24
    v_dot2_f32_bf16 v24, v43, v18, v24
K1H_S5_2b:
    s_cmp_eq_u32 s54, 0
    s_cbranch_scc1 K1H_S5_2c
    v_dot2_f32_bf16 v25, v32, v216, v25
    v_dot2_f32_bf16 v25, v33, v217, v25
    v_dot2_f32_bf16 v25, v34, v218, v25
    v_dot2_f32_bf16 v25, v35, v219, v25
    v_dot2_f32_bf16 v26, v36, v216, v26
    v_dot2_f32_bf16 v26, v37, v217, v26
    v_dot2_f32_bf16 v26, v38, v218, v26
    v_dot2_f32_bf16 v26, v39, v219, v26
K1H_S5_2c:
    s_waitcnt vmcnt(0)
    s_barrier
    s_setprio 3
    ds_read_b128 v[32:35], v12 offset:0
    ds_read_b128 v[36:39], v12 offset:4096
    ds_read_b64_tr_b16 v[40:41], v15 offset:16384
    ds_read_b64_tr_b16 v[42:43], v15 offset:17408
    s_waitcnt lgkmcnt(4)
    v_mfma_f32_32x32x16_bf16 v[64:79], v[52:55], v[44:47], v[64:79]
    v_mfma_f32_32x32x16_bf16 v[80:95], v[52:55], v[48:51], v[80:95]
    s_cmp_lg_u32 s53, 3
    s_cbranch_scc1 K1H_S5_3a
    v_dot2_f32_bf16 v20, v44, v18, v20
    v_dot2_f32_bf16 v22, v44, v44, v22
    v_dot2_f32_bf16 v20, v45, v18, v20
    v_dot2_f32_bf16 v22, v45, v45, v22
    v_dot2_f32_bf16 v20, v46, v18, v20
    v_dot2_f32_bf16 v22, v46, v46, v22
    v_dot2_f32_bf16 v20, v47, v18, v20
    v_dot2_f32_bf16 v22, v47, v47, v22
    v_dot2_f32_bf16 v21, v48, v18, v21
    v_dot2_f32_bf16 v23, v48, v48, v23
    v_dot2_f32_bf16 v21, v49, v18, v21
    v_dot2_f32_bf16 v23, v49, v49, v23
    v_dot2_f32_bf16 v21, v50, v18, v21
    v_dot2_f32_bf16 v23, v50, v50, v23
    v_dot2_f32_bf16 v21, v51, v18, v21
    v_dot2_f32_bf16 v23, v51, v51, v23
K1H_S5_3a:
    s_cmp_lg_u32 s52, 1
    s_cbranch_scc1 K1H_S5_3b
    v_dot2_f32_bf16 v24, v52, v18, v24
    v_dot2_f32_bf16 v24, v53, v18, v24
    v_dot2_f32_bf16 v24, v54, v18, v24
    v_dot2_f32_bf16 v24, v55, v18, v24
K1H_S5_3b:
    s_cmp_eq_u32 s54, 0
    s_cbranch_scc1 K1H_S5_3c
    v_dot2_f32_bf16 v25, v44, v220, v25
    v_dot2_f32_bf16 v25, v45, v221, v25
    v_dot2_f32_bf16 v25, v46, v222, v25
    v_dot2_f32_bf16 v25, v47, v223, v25
    v_dot2_f32_bf16 v26, v48, v220, v26
    v_dot2_f32_bf16 v26, v49, v221, v26
    v_dot2_f32_bf16 v26, v50, v222, v26
    v_dot2_f32_bf16 v26, v51, v223, v26
K1H_S5_3c:
    s_setprio 2
    ds_read_b128 v[44:47], v13 offset:0
    ds_read_b128 v[48:51], v13 offset:4096
    ds_read_b64_tr_b16 v[52:53], v15 offset:20480
    ds_read_b64_tr_b16 v[54:55], v15 offset:21504
    s_waitcnt lgkmcnt(4)
    v_mfma_f32_32x32x16_bf16 v[64:79], v[40:43], v[32:35], v[64:79]
    v_mfma_f32_32x32x16_bf16 v[80:95], v[40:43], v[36:39], v[80:95]
    s_cmp_lg_u32 s53, 0
    s_cbranch_scc1 K1H_S6_0a
    v_dot2_f32_bf16 v20, v32, v18, v20
    v_dot2_f32_bf16 v22, v32, v32, v22
    v_dot2_f32_bf16 v20, v33, v18, v20
    v_dot2_f32_bf16 v22, v33, v33, v22
    v_dot2_f32_bf16 v20, v34, v18, v20
    v_dot2_f32_bf16 v22, v34, v34, v22
    v_dot2_f32_bf16 v20, v35, v18, v20
    v_dot2_f32_bf16 v22, v35, v35, v22
    v_dot2_f32_bf16 v21, v36, v18, v21
    v_dot2_f32_bf16 v23, v36, v36, v23
    v_dot2_f32_bf16 v21, v37, v18, v21
    v_dot2_f32_bf16 v23, v37, v37, v23
    v_dot2_f32_bf16 v21, v38, v18, v21
    v_dot2_f32_bf16 v23, v38, v38, v23
    v_dot2_f32_bf16 v21, v39, v18, v21
    v_dot2_f32_bf16 v23, v39, v39, v23
K1H_S6_0a:
    s_cmp_lg_u32 s52, 0
    s_cbranch_scc1 K1H_S6_0b
    v_dot2_f32_bf16 v24, v40, v18, v24
    v_dot2_f32_bf16 v24, v41, v18, v24
    v_dot2_f32_bf16 v24, v42, v18, v24
    v_dot2_f32_bf16 v24, v43, v18, v24
K1H_S6_0b:
    s_cmp_eq_u32 s54, 0
    s_cbranch_scc1 K1H_S6_0c
    v_dot2_f32_bf16 v25, v32, v224, v25
    v_dot2_f32_bf16 v25, v33, v225, v25
    v_dot2_f32_bf16 v25, v34, v226, v25
    v_dot2_f32_bf16 v25, v35, v227, v25
    v_dot2_f32_bf16 v26, v36, v224, v26
    v_dot2_f32_bf16 v26, v37, v225, v26
    v_dot2_f32_bf16 v26, v38, v226, v26
    v_dot2_f32_bf16 v26, v39, v227, v26
K1H_S6_0c:
    s_setprio 1
    ds_read_b128 v[32:35], v12 offset:1024
    ds_read_b128 v[36:39], v12 offset:5120
    ds_read_b64_tr_b16 v[40:41], v15 offset:24576
    ds_read_b64_tr_b16 v[42:43], v15 offset:25600
    s_waitcnt lgkmcnt(4)
    v_mfma_f32_32x32x16_bf16 v[64:79], v[52:55], v[44:47], v[64:79]
    v_mfma_f32_32x32x16_bf16 v[80:95], v[52:55], v[48:51], v[80:95]
    s_cmp_lg_u32 s53, 1
    s_cbranch_scc1 K1H_S6_1a
    v_dot2_f32_bf16 v20, v44, v18, v20
    v_dot2_f32_bf16 v22, v44, v44, v22
    v_dot2_f32_bf16 v20, v45, v18, v20
    v_dot2_f32_bf16 v22, v45, v45, v22
    v_dot2_f32_bf16 v20, v46, v18, v20
    v_dot2_f32_bf16 v22, v46, v46, v22
    v_dot2_f32_bf16 v20, v47, v18, v20
    v_dot2_f32_bf16 v22, v47, v47, v22
    v_dot2_f32_bf16 v21, v48, v18, v21
    v_dot2_f32_bf16 v23, v48, v48, v23
    v_dot2_f32_bf16 v21, v49, v18, v21
    v_dot2_f32_bf16 v23, v49, v49, v23
    v_dot2_f32_bf16 v21, v50, v18, v21
    v_dot2_f32_bf16 v23, v50, v50, v23
    v_dot2_f32_bf16 v21, v51, v18, v21
    v_dot2_f32_bf16 v23, v51, v51, v23
K1H_S6_1a:
    s_cmp_lg_u32 s52, 1
    s_cbranch_scc1 K1H_S6_1b
    v_dot2_f32_bf16 v24, v52, v18, v24
    v_dot2_f32_bf16 v24, v53, v18, v24
    v_dot2_f32_bf16 v24, v54, v18, v24
    v_dot2_f32_bf16 v24, v55, v18, v24
K1H_S6_1b:
    s_cmp_eq_u32 s54, 0
    s_cbranch_scc1 K1H_S6_1c
    v_dot2_f32_bf16 v25, v44, v228, v25
    v_dot2_f32_bf16 v25, v45, v229, v25
    v_dot2_f32_bf16 v25, v46, v230, v25
    v_dot2_f32_bf16 v25, v47, v231, v25
    v_dot2_f32_bf16 v26, v48, v228, v26
    v_dot2_f32_bf16 v26, v49, v229, v26
    v_dot2_f32_bf16 v26, v50, v230, v26
    v_dot2_f32_bf16 v26, v51, v231, v26
K1H_S6_1c:
    s_setprio 0
    ds_read_b128 v[44:47], v13 offset:1024
    ds_read_b128 v[48:51], v13 offset:5120
    ds_read_b64_tr_b16 v[52:53], v15 offset:28672
    ds_read_b64_tr_b16 v[54:55], v15 offset:29696
    s_waitcnt lgkmcnt(4)
    v_mfma_f32_32x32x16_bf16 v[64:79], v[40:43], v[32:35], v[64:79]
    v_mfma_f32_32x32x16_bf16 v[80:95], v[40:43], v[36:39], v[80:95]
    s_cmp_lg_u32 s53, 2
    s_cbranch_scc1 K1H_S6_2a
    v_dot2_f32_bf16 v20, v32, v18, v20
    v_dot2_f32_bf16 v22, v32, v32, v22
    v_dot2_f32_bf16 v20, v33, v18, v20
    v_dot2_f32_bf16 v22, v33, v33, v22
    v_dot2_f32_bf16 v20, v34, v18, v20
    v_dot2_f32_bf16 v22, v34, v34, v22
    v_dot2_f32_bf16 v20, v35, v18, v20
    v_dot2_f32_bf16 v22, v35, v35, v22
    v_dot2_f32_bf16 v21, v36, v18, v21
    v_dot2_f32_bf16 v23, v36, v36, v23
    v_dot2_f32_bf16 v21, v37, v18, v21
    v_dot2_f32_bf16 v23, v37, v37, v23
    v_dot2_f32_bf16 v21, v38, v18, v21
    v_dot2_f32_bf16 v23, v38, v38, v23
    v_dot2_f32_bf16 v21, v39, v18, v21
    v_dot2_f32_bf16 v23, v39, v39, v23
K1H_S6_2a:
    s_cmp_lg_u32 s52, 0
    s_cbranch_scc1 K1H_S6_2b
    v_dot2_f32_bf16 v24, v40, v18, v24
    v_dot2_f32_bf16 v24, v41, v18, v24
    v_dot2_f32_bf16 v24, v42, v18, v24
    v_dot2_f32_bf16 v24, v43, v18, v24
K1H_S6_2b:
    s_cmp_eq_u32 s54, 0
    s_cbranch_scc1 K1H_S6_2c
    v_dot2_f32_bf16 v25, v32, v232, v25
    v_dot2_f32_bf16 v25, v33, v233, v25
    v_dot2_f32_bf16 v25, v34, v234, v25
    v_dot2_f32_bf16 v25, v35, v235, v25
    v_dot2_f32_bf16 v26, v36, v232, v26
    v_dot2_f32_bf16 v26, v37, v233, v26
    v_dot2_f32_bf16 v26, v38, v234, v26
    v_dot2_f32_bf16 v26, v39, v235, v26
K1H_S6_2c:
    s_waitcnt lgkmcnt(0)
    v_mfma_f32_32x32x16_bf16 v[64:79], v[52:55], v[44:47], v[64:79]
    v_mfma_f32_32x32x16_bf16 v[80:95], v[52:55], v[48:51], v[80:95]
    s_cmp_lg_u32 s53, 3
    s_cbranch_scc1 K1H_S6_3a
    v_dot2_f32_bf16 v20, v44, v18, v20
    v_dot2_f32_bf16 v22, v44, v44, v22
    v_dot2_f32_bf16 v20, v45, v18, v20
    v_dot2_f32_bf16 v22, v45, v45, v22
    v_dot2_f32_bf16 v20, v46, v18, v20
    v_dot2_f32_bf16 v22, v46, v46, v22
    v_dot2_f32_bf16 v20, v47, v18, v20
    v_dot2_f32_bf16 v22, v47, v47, v22
    v_dot2_f32_bf16 v21, v48, v18, v21
    v_dot2_f32_bf16 v23, v48, v48, v23
    v_dot2_f32_bf16 v21, v49, v18, v21
    v_dot2_f32_bf16 v23, v49, v49, v23
    v_dot2_f32_bf16 v21, v50, v18, v21
    v_dot2_f32_bf16 v23, v50, v50, v23
    v_dot2_f32_bf16 v21, v51, v18, v21
    v_dot2_f32_bf16 v23, v51, v51, v23
K1H_S6_3a:
    s_cmp_lg_u32 s52, 1
    s_cbranch_scc1 K1H_S6_3b
    v_dot2_f32_bf16 v24, v52, v18, v24
    v_dot2_f32_bf16 v24, v53, v18, v24
    v_dot2_f32_bf16 v24, v54, v18, v24
    v_dot2_f32_bf16 v24, v55, v18, v24
K1H_S6_3b:
    s_cmp_eq_u32 s54, 0
    s_cbranch_scc1 K1H_S6_3c
    v_dot2_f32_bf16 v25, v44, v236, v25
    v_dot2_f32_bf16 v25, v45, v237, v25
    v_dot2_f32_bf16 v25, v46, v238, v25
    v_dot2_f32_bf16 v25, v47, v239, v25
    v_dot2_f32_bf16 v26, v48, v236, v26
    v_dot2_f32_bf16 v26, v49, v237, v26
    v_dot2_f32_bf16 v26, v50, v238, v26
    v_dot2_f32_bf16 v26, v51, v239, v26
K1H_S6_3c:
    s_cmp_eq_u32 s54, 0
    s_cbranch_scc1 K1_NOGATE
    v_mov_b32 v32, v25
    v_mov_b32 v33, v26
    v_mov_b32 v34, v25
    v_mov_b32 v35, v26
    s_nop 1
    v_permlane32_swap_b32 v32, v34
    v_permlane32_swap_b32 v33, v35
    v_add_f32 v32, v32, v34
    v_add_f32 v33, v33, v35
    v_mul_f32 v32, 0xbfb8aa3b, v32
    v_mul_f32 v33, 0xbfb8aa3b, v33
    v_exp_f32 v32, v32
    v_exp_f32 v33, v33
    v_and_b32 v34, 31, v1
    v_add_f32 v32, 1.0, v32
    v_add_f32 v33, 1.0, v33
    v_rcp_f32 v32, v32
    v_rcp_f32 v33, v33
    v_lshlrev_b32 v34, 2, v34
    s_lshl_b32 s35, s24, 9
    s_lshl_b32 s36, s52, 8
    s_add_u32 s35, s35, s36
    s_add_u32 s35, s35, 29360128
    buffer_store_dword v32, v34, s[20:23], s35 offen
    buffer_store_dword v33, v34, s[20:23], s35 offen offset:128
K1_NOGATE:
    v_mov_b32 v26, v20
    v_mov_b32 v27, v21
    v_mov_b32 v28, v22
    v_mov_b32 v29, v23
    v_mov_b32 v30, v24
    s_nop 1
    v_permlane32_swap_b32 v20, v26
    v_permlane32_swap_b32 v21, v27
    v_permlane32_swap_b32 v22, v28
    v_permlane32_swap_b32 v23, v29
    v_permlane32_swap_b32 v24, v30
    v_add_f32 v20, v20, v26
    v_add_f32 v21, v21, v27
    v_add_f32 v22, v22, v28
    v_add_f32 v23, v23, v29
    v_add_f32 v24, v24, v30
    v_and_b32 v2, 31, v1
    v_lshlrev_b32 v2, 2, v2
    s_lshl_b32 s35, s52, 11
    s_lshl_b32 s36, s53, 9
    s_add_u32 s36, s36, s35
    s_add_u32 s36, s36, 98304
    v_add_u32 v3, s36, v2
    ds_write_b32 v3, v20
    ds_write_b32 v3, v21 offset:128
    ds_write_b32 v3, v22 offset:256
    ds_write_b32 v3, v23 offset:384
    s_lshl_b32 s36, s53, 8
    s_lshl_b32 s37, s52, 7
    s_add_u32 s37, s37, s36
    s_add_u32 s37, s37, 102400
    v_add_u32 v3, s37, v2
    ds_write_b32 v3, v24
    s_add_u32 s35, s35, 98304
    v_add_u32 v3, s35, v2
    v_lshrrev_b32 v4, 5, v1
    v_lshlrev_b32 v4, 4, v4
    s_add_u32 s36, s36, 102400
    v_add_u32 v4, s36, v4
    s_waitcnt lgkmcnt(0)
    s_barrier
    ds_read_b32 v32, v3 offset:0
    ds_read_b32 v33, v3 offset:128
    ds_read_b32 v34, v3 offset:256
    ds_read_b32 v35, v3 offset:384
    ds_read_b32 v36, v3 offset:512
    ds_read_b32 v37, v3 offset:640
    ds_read_b32 v38, v3 offset:768
    ds_read_b32 v39, v3 offset:896
    ds_read_b32 v40, v3 offset:1024
    ds_read_b32 v41, v3 offset:1152
    ds_read_b32 v42, v3 offset:1280
    ds_read_b32 v43, v3 offset:1408
    ds_read_b32 v44, v3 offset:1536
    ds_read_b32 v45, v3 offset:1664
    ds_read_b32 v46, v3 offset:1792
    ds_read_b32 v47, v3 offset:1920
    ds_read_b128 v[96:99], v4 offset:0
    ds_read_b128 v[112:115], v4 offset:128
    ds_read_b128 v[100:103], v4 offset:32
    ds_read_b128 v[116:119], v4 offset:160
    ds_read_b128 v[104:107], v4 offset:64
    ds_read_b128 v[120:123], v4 offset:192
    ds_read_b128 v[108:111], v4 offset:96
    ds_read_b128 v[124:127], v4 offset:224
    s_waitcnt lgkmcnt(8)
    v_add_f32 v20, v32, v36
    v_add_f32 v40, v40, v44
    v_add_f32 v21, v33, v37
    v_add_f32 v41, v41, v45
    v_add_f32 v22, v34, v38
    v_add_f32 v42, v42, v46
    v_add_f32 v23, v35, v39
    v_add_f32 v43, v43, v47
    v_add_f32 v20, v20, v40
    v_add_f32 v21, v21, v41
    v_add_f32 v22, v22, v42
    v_add_f32 v23, v23, v43
    v_mul_f32 v20, 0x3b124925, v20
    v_mul_f32 v21, 0x3b124925, v21
    v_mul_f32 v22, 0x3b124925, v22
    v_mul_f32 v23, 0x3b124925, v23
    v_fma_f32 v22, -v20, v20, v22
    v_fma_f32 v23, -v21, v21, v23
    v_max_f32 v22, 0, v22
    v_max_f32 v23, 0, v23
    v_add_f32 v22, 0x3727c5ac, v22
    v_add_f32 v23, 0x3727c5ac, v23
    v_rsq_f32 v22, v22
    v_rsq_f32 v23, v23
    s_waitcnt lgkmcnt(0)
    v_add_f32 v96, v96, v112
    v_add_f32 v97, v97, v113
    v_add_f32 v98, v98, v114
    v_add_f32 v99, v99, v115
    v_add_f32 v100, v100, v116
    v_add_f32 v101, v101, v117
    v_add_f32 v102, v102, v118
    v_add_f32 v103, v103, v119
    v_add_f32 v104, v104, v120
    v_add_f32 v105, v105, v121
    v_add_f32 v106, v106, v122
    v_add_f32 v107, v107, v123
    v_add_f32 v108, v108, v124
    v_add_f32 v109, v109, v125
    v_add_f32 v110, v110, v126
    v_add_f32 v111, v111, v127
    s_sub_u32 s48, s25, 12
    s_lshl_b32 s48, s48, 2
    s_add_u32 s48, s48, s53
    s_lshl_b32 s49, s48, 11
    s_lshl_b32 s50, s24, 2
    s_lshl_b32 s35, s52, 1
    s_add_u32 s50, s50, s35
    s_mul_i32 s50, s50, 28672
    s_add_u32 s49, s49, s50
    s_add_u32 s49, s49, 6291456
    v_lshlrev_b32 v2, 4, v1
    s_cmp_ge_u32 s48, 14
    s_cbranch_scc1 K1_RSTORE
    v_mov_b32 v28, 0xbdd2d3e8
    v_mov_b32 v29, 0xbdd2d3e8
    v_mov_b32 v30, 0xc0135761
    v_mov_b32 v31, 0xc0135761
    v_fma_f32 v64, -v20, v96, v64
    v_fma_f32 v65, -v20, v97, v65
    v_fma_f32 v66, -v20, v98, v66
    v_fma_f32 v67, -v20, v99, v67
    v_fma_f32 v68, -v20, v100, v68
    v_fma_f32 v69, -v20, v101, v69
    v_fma_f32 v70, -v20, v102, v70
    v_fma_f32 v71, -v20, v103, v71
    v_fma_f32 v72, -v20, v104, v72
    v_fma_f32 v73, -v20, v105, v73
    v_fma_f32 v74, -v20, v106, v74
    v_fma_f32 v75, -v20, v107, v75
    v_fma_f32 v76, -v20, v108, v76
    v_fma_f32 v77, -v20, v109, v77
    v_fma_f32 v78, -v20, v110, v78
    v_fma_f32 v79, -v20, v111, v79
    v_mul_f32 v64, v22, v64
    v_mul_f32 v65, v22, v65
    v_mul_f32 v66, v22, v66
    v_mul_f32 v67, v22, v67
    v_mul_f32 v68, v22, v68
    v_mul_f32 v69, v22, v69
    v_mul_f32 v70, v22, v70
    v_mul_f32 v71, v22, v71
    v_mul_f32 v72, v22, v72
    v_mul_f32 v73, v22, v73
    v_mul_f32 v74, v22, v74
    v_mul_f32 v75, v22, v75
    v_mul_f32 v76, v22, v76
    v_mul_f32 v77, v22, v77
    v_mul_f32 v78, v22, v78
    v_mul_f32 v79, v22, v79
    v_pk_mul_f32 v[40:41], v[64:65], v[64:65]
    v_pk_mul_f32 v[42:43], v[66:67], v[66:67]
    v_pk_mul_f32 v[44:45], v[68:69], v[68:69]
    v_pk_mul_f32 v[46:47], v[70:71], v[70:71]
    v_pk_mul_f32 v[48:49], v[72:73], v[72:73]
    v_pk_mul_f32 v[50:51], v[74:75], v[74:75]
    v_pk_mul_f32 v[52:53], v[76:77], v[76:77]
    v_pk_mul_f32 v[54:55], v[78:79], v[78:79]
    v_pk_fma_f32 v[40:41], v[40:41], v[28:29], v[30:31]
    v_pk_fma_f32 v[42:43], v[42:43], v[28:29], v[30:31]
    v_pk_fma_f32 v[44:45], v[44:45], v[28:29], v[30:31]
    v_pk_fma_f32 v[46:47], v[46:47], v[28:29], v[30:31]
    v_pk_fma_f32 v[48:49], v[48:49], v[28:29], v[30:31]
    v_pk_fma_f32 v[50:51], v[50:51], v[28:29], v[30:31]
    v_pk_fma_f32 v[52:53], v[52:53], v[28:29], v[30:31]
    v_pk_fma_f32 v[54:55], v[54:55], v[28:29], v[30:31]
    v_pk_mul_f32 v[40:41], v[40:41], v[64:65]
    v_pk_mul_f32 v[42:43], v[42:43], v[66:67]
    v_pk_mul_f32 v[44:45], v[44:45], v[68:69]
    v_pk_mul_f32 v[46:47], v[46:47], v[70:71]
    v_pk_mul_f32 v[48:49], v[48:49], v[72:73]
    v_pk_mul_f32 v[50:51], v[50:51], v[74:75]
    v_pk_mul_f32 v[52:53], v[52:53], v[76:77]
    v_pk_mul_f32 v[54:55], v[54:55], v[78:79]
    v_exp_f32 v40, v40
    v_exp_f32 v41, v41
    v_exp_f32 v42, v42
    v_exp_f32 v43, v43
    v_exp_f32 v44, v44
    v_exp_f32 v45, v45
    v_exp_f32 v46, v46
    v_exp_f32 v47, v47
    v_exp_f32 v48, v48
    v_exp_f32 v49, v49
    v_exp_f32 v50, v50
    v_exp_f32 v51, v51
    v_exp_f32 v52, v52
    v_exp_f32 v53, v53
    v_exp_f32 v54, v54
    v_exp_f32 v55, v55
    v_pk_add_f32 v[40:41], v[40:41], 1.0 op_sel_hi:[1,0]
    v_pk_add_f32 v[42:43], v[42:43], 1.0 op_sel_hi:[1,0]
    v_pk_add_f32 v[44:45], v[44:45], 1.0 op_sel_hi:[1,0]
    v_pk_add_f32 v[46:47], v[46:47], 1.0 op_sel_hi:[1,0]
    v_pk_add_f32 v[48:49], v[48:49], 1.0 op_sel_hi:[1,0]
    v_pk_add_f32 v[50:51], v[50:51], 1.0 op_sel_hi:[1,0]
    v_pk_add_f32 v[52:53], v[52:53], 1.0 op_sel_hi:[1,0]
    v_pk_add_f32 v[54:55], v[54:55], 1.0 op_sel_hi:[1,0]
    v_rcp_f32 v40, v40
    v_rcp_f32 v41, v41
    v_rcp_f32 v42, v42
    v_rcp_f32 v43, v43
    v_rcp_f32 v44, v44
    v_rcp_f32 v45, v45
    v_rcp_f32 v46, v46
    v_rcp_f32 v47, v47
    v_rcp_f32 v48, v48
    v_rcp_f32 v49, v49
    v_rcp_f32 v50, v50
    v_rcp_f32 v51, v51
    v_rcp_f32 v52, v52
    v_rcp_f32 v53, v53
    v_rcp_f32 v54, v54
    v_rcp_f32 v55, v55
    v_pk_mul_f32 v[64:65], v[64:65], v[40:41]
    v_pk_mul_f32 v[66:67], v[66:67], v[42:43]
    v_pk_mul_f32 v[68:69], v[68:69], v[44:45]
    v_pk_mul_f32 v[70:71], v[70:71], v[46:47]
    v_pk_mul_f32 v[72:73], v[72:73], v[48:49]
    v_pk_mul_f32 v[74:75], v[74:75], v[50:51]
    v_pk_mul_f32 v[76:77], v[76:77], v[52:53]
    v_pk_mul_f32 v[78:79], v[78:79], v[54:55]
    v_cvt_pk_bf16_f32 v32, v64, v65
    v_cvt_pk_bf16_f32 v33, v66, v67
    v_cvt_pk_bf16_f32 v34, v68, v69
    v_cvt_pk_bf16_f32 v35, v70, v71
    v_cvt_pk_bf16_f32 v36, v72, v73
    v_cvt_pk_bf16_f32 v37, v74, v75
    v_cvt_pk_bf16_f32 v38, v76, v77
    v_cvt_pk_bf16_f32 v39, v78, v79
    s_add_u32 s50, s49, 0
    buffer_store_dwordx4 v[32:35], v2, s[20:23], s50 offen
    buffer_store_dwordx4 v[36:39], v2, s[20:23], s50 offen offset:1024
    s_nop 1
    v_fma_f32 v80, -v21, v96, v80
    v_fma_f32 v81, -v21, v97, v81
    v_fma_f32 v82, -v21, v98, v82
    v_fma_f32 v83, -v21, v99, v83
    v_fma_f32 v84, -v21, v100, v84
    v_fma_f32 v85, -v21, v101, v85
    v_fma_f32 v86, -v21, v102, v86
    v_fma_f32 v87, -v21, v103, v87
    v_fma_f32 v88, -v21, v104, v88
    v_fma_f32 v89, -v21, v105, v89
    v_fma_f32 v90, -v21, v106, v90
    v_fma_f32 v91, -v21, v107, v91
    v_fma_f32 v92, -v21, v108, v92
    v_fma_f32 v93, -v21, v109, v93
    v_fma_f32 v94, -v21, v110, v94
    v_fma_f32 v95, -v21, v111, v95
    v_mul_f32 v80, v23, v80
    v_mul_f32 v81, v23, v81
    v_mul_f32 v82, v23, v82
    v_mul_f32 v83, v23, v83
    v_mul_f32 v84, v23, v84
    v_mul_f32 v85, v23, v85
    v_mul_f32 v86, v23, v86
    v_mul_f32 v87, v23, v87
    v_mul_f32 v88, v23, v88
    v_mul_f32 v89, v23, v89
    v_mul_f32 v90, v23, v90
    v_mul_f32 v91, v23, v91
    v_mul_f32 v92, v23, v92
    v_mul_f32 v93, v23, v93
    v_mul_f32 v94, v23, v94
    v_mul_f32 v95, v23, v95
    v_pk_mul_f32 v[40:41], v[80:81], v[80:81]
    v_pk_mul_f32 v[42:43], v[82:83], v[82:83]
    v_pk_mul_f32 v[44:45], v[84:85], v[84:85]
    v_pk_mul_f32 v[46:47], v[86:87], v[86:87]
    v_pk_mul_f32 v[48:49], v[88:89], v[88:89]
    v_pk_mul_f32 v[50:51], v[90:91], v[90:91]
    v_pk_mul_f32 v[52:53], v[92:93], v[92:93]
    v_pk_mul_f32 v[54:55], v[94:95], v[94:95]
    v_pk_fma_f32 v[40:41], v[40:41], v[28:29], v[30:31]
    v_pk_fma_f32 v[42:43], v[42:43], v[28:29], v[30:31]
    v_pk_fma_f32 v[44:45], v[44:45], v[28:29], v[30:31]
    v_pk_fma_f32 v[46:47], v[46:47], v[28:29], v[30:31]
    v_pk_fma_f32 v[48:49], v[48:49], v[28:29], v[30:31]
    v_pk_fma_f32 v[50:51], v[50:51], v[28:29], v[30:31]
    v_pk_fma_f32 v[52:53], v[52:53], v[28:29], v[30:31]
    v_pk_fma_f32 v[54:55], v[54:55], v[28:29], v[30:31]
    v_pk_mul_f32 v[40:41], v[40:41], v[80:81]
    v_pk_mul_f32 v[42:43], v[42:43], v[82:83]
    v_pk_mul_f32 v[44:45], v[44:45], v[84:85]
    v_pk_mul_f32 v[46:47], v[46:47], v[86:87]
    v_pk_mul_f32 v[48:49], v[48:49], v[88:89]
    v_pk_mul_f32 v[50:51], v[50:51], v[90:91]
    v_pk_mul_f32 v[52:53], v[52:53], v[92:93]
    v_pk_mul_f32 v[54:55], v[54:55], v[94:95]
    v_exp_f32 v40, v40
    v_exp_f32 v41, v41
    v_exp_f32 v42, v42
    v_exp_f32 v43, v43
    v_exp_f32 v44, v44
    v_exp_f32 v45, v45
    v_exp_f32 v46, v46
    v_exp_f32 v47, v47
    v_exp_f32 v48, v48
    v_exp_f32 v49, v49
    v_exp_f32 v50, v50
    v_exp_f32 v51, v51
    v_exp_f32 v52, v52
    v_exp_f32 v53, v53
    v_exp_f32 v54, v54
    v_exp_f32 v55, v55
    v_pk_add_f32 v[40:41], v[40:41], 1.0 op_sel_hi:[1,0]
    v_pk_add_f32 v[42:43], v[42:43], 1.0 op_sel_hi:[1,0]
    v_pk_add_f32 v[44:45], v[44:45], 1.0 op_sel_hi:[1,0]
    v_pk_add_f32 v[46:47], v[46:47], 1.0 op_sel_hi:[1,0]
    v_pk_add_f32 v[48:49], v[48:49], 1.0 op_sel_hi:[1,0]
    v_pk_add_f32 v[50:51], v[50:51], 1.0 op_sel_hi:[1,0]
    v_pk_add_f32 v[52:53], v[52:53], 1.0 op_sel_hi:[1,0]
    v_pk_add_f32 v[54:55], v[54:55], 1.0 op_sel_hi:[1,0]
    v_rcp_f32 v40, v40
    v_rcp_f32 v41, v41
    v_rcp_f32 v42, v42
    v_rcp_f32 v43, v43
    v_rcp_f32 v44, v44
    v_rcp_f32 v45, v45
    v_rcp_f32 v46, v46
    v_rcp_f32 v47, v47
    v_rcp_f32 v48, v48
    v_rcp_f32 v49, v49
    v_rcp_f32 v50, v50
    v_rcp_f32 v51, v51
    v_rcp_f32 v52, v52
    v_rcp_f32 v53, v53
    v_rcp_f32 v54, v54
    v_rcp_f32 v55, v55
    v_pk_mul_f32 v[80:81], v[80:81], v[40:41]
    v_pk_mul_f32 v[82:83], v[82:83], v[42:43]
    v_pk_mul_f32 v[84:85], v[84:85], v[44:45]
    v_pk_mul_f32 v[86:87], v[86:87], v[46:47]
    v_pk_mul_f32 v[88:89], v[88:89], v[48:49]
    v_pk_mul_f32 v[90:91], v[90:91], v[50:51]
    v_pk_mul_f32 v[92:93], v[92:93], v[52:53]
    v_pk_mul_f32 v[94:95], v[94:95], v[54:55]
    v_cvt_pk_bf16_f32 v32, v80, v81
    v_cvt_pk_bf16_f32 v33, v82, v83
    v_cvt_pk_bf16_f32 v34, v84, v85
    v_cvt_pk_bf16_f32 v35, v86, v87
    v_cvt_pk_bf16_f32 v36, v88, v89
    v_cvt_pk_bf16_f32 v37, v90, v91
    v_cvt_pk_bf16_f32 v38, v92, v93
    v_cvt_pk_bf16_f32 v39, v94, v95
    s_add_u32 s50, s49, 28672
    buffer_store_dwordx4 v[32:35], v2, s[20:23], s50 offen
    buffer_store_dwordx4 v[36:39], v2, s[20:23], s50 offen offset:1024
    s_nop 1
K1_RSTORE:
    s_cmp_lg_u32 s34, 0
    s_cbranch_scc1 K1_NOZ
    v_lshlrev_b32 v2, 8, v1
    v_mov_b32 v3, 0
    s_mov_b32 s35, 32505856
    buffer_store_dword v3, v2, s[20:23], s35 offen
K1_NOZ:
    v_lshlrev_b32 v2, 4, v1
    s_cmp_eq_u32 s56, -1
    s_cbranch_scc1 K1_RS0
    v_lshl_or_b32 v240, v241, 16, v240
    v_lshl_or_b32 v241, v243, 16, v242
    v_lshl_or_b32 v242, v245, 16, v244
    v_lshl_or_b32 v243, v247, 16, v246
    buffer_store_dwordx4 v[240:243], v2, s[20:23], s56 offen
    s_cmp_ge_u32 s34, 1568
    s_cbranch_scc1 K1_RS0
    v_mov_b32 v18, 0x3f803f80
    v_mov_b32 v4, 0
    v_dot2_f32_bf16 v4, v240, v18, v4
    v_dot2_f32_bf16 v4, v241, v18, v4
    v_dot2_f32_bf16 v4, v242, v18, v4
    v_dot2_f32_bf16 v4, v243, v18, v4
    s_nop 3
    v_mov_b32 v5, v4
    s_nop 1
    v_permlane32_swap_b32 v4, v5
    v_add_f32 v4, v4, v5
    v_and_b32 v5, 31, v1
    v_lshlrev_b32 v5, 2, v5
    s_lshl_b32 s35, s34, 7
    s_add_u32 s35, s35, 30408704
    buffer_store_dword v4, v5, s[20:23], s35 offen
K1_RS0:
    s_cmp_eq_u32 s57, -1
    s_cbranch_scc1 K1_RS1
    v_lshl_or_b32 v248, v249, 16, v248
    v_lshl_or_b32 v249, v251, 16, v250
    v_lshl_or_b32 v250, v253, 16, v252
    v_lshl_or_b32 v251, v255, 16, v254
    buffer_store_dwordx4 v[248:251], v2, s[20:23], s57 offen
K1_RS1:
K1_END:
    s_endpgm
.section .rodata,"a"
.p2align 6
.amdhsa_kernel k1_kernel
  .amdhsa_next_free_vgpr 256
  .amdhsa_next_free_sgpr 102
  .amdhsa_accum_offset 256
  .amdhsa_group_segment_fixed_size 0
  .amdhsa_kernarg_size 96
  .amdhsa_user_sgpr_count 2
  .amdhsa_user_sgpr_kernarg_segment_ptr 1
  .amdhsa_system_sgpr_workgroup_id_x 1
.end_amdhsa_kernel
.text
.globl km_kernel
.p2align 8
.type km_kernel,@function
km_kernel:
    s_cmp_ge_u32 s2, 480
    s_cbranch_scc1 KM_END
    s_load_dwordx2 s[4:5], s[0:1], 0
    s_load_dwordx2 s[64:65], s[0:1], 72
    s_load_dwordx2 s[6:7], s[0:1], 88
    v_and_b32 v1, 63, v0
    v_lshrrev_b32 v2, 6, v0
    s_nop 0
    v_readfirstlane_b32 s26, v2
    s_mov_b32 s60, 0
    s_mov_b32 s61, -1
    v_lshlrev_b32 v2, 4, v1
    s_waitcnt lgkmcnt(0)
    s_mov_b32 s20, s6
    s_and_b32 s21, s7, 0xffff
    s_mov_b32 s22, 268435456
    s_mov_b32 s23, 0x00020000
    s_mov_b32 s40, 0
    s_mov_b32 s41, 4096
    s_mov_b32 s42, 8192
    s_mov_b32 s43, 12288
    s_mov_b32 s44, 16384
    s_mov_b32 s45, 20480
    s_mov_b32 s46, 24576
    v_lshlrev_b32 v0, 7, v1
    s_cmp_ge_u32 s2, 224
    s_cbranch_scc1 KM_ATTN
    s_setprio 3
    s_and_b32 s24, s2, 31
    s_lshr_b32 s25, s2, 5
    s_and_b32 s46, s26, 3
    s_lshr_b32 s47, s26, 2
    s_add_u32 s12, s6, 6291456
    s_addc_u32 s13, s7, 0
    s_and_b32 s13, s13, 0xffff
    s_mov_b32 s14, 1835008
    s_mov_b32 s15, 0x00020000
    s_mov_b32 s16, s4
    s_and_b32 s17, s5, 0xffff
    s_mov_b32 s18, 1835008
    s_mov_b32 s19, 0x00020000
    s_lshr_b32 s35, s46, 1
    s_add_u32 s35, s35, 1
    s_sub_u32 s36, 0, s35
    s_and_b32 s37, s46, 1
    s_cmp_lg_u32 s37, 0
    s_cselect_b32 s35, s35, s36
    s_mul_i32 s38, s46, 7168
    s_lshl_b32 s27, s24, 1
    s_add_u32 s27, s27, s47
    s_lshl_b32 s36, s27, 5
    s_add_u32 s36, s36, s35
    v_and_b32 v3, 31, v1
    v_add_u32 v3, s36, v3
    v_and_b32 v5, 32, v1
    v_lshrrev_b32 v6, 5, v3
    v_mul_u32_u24 v6, 28672, v6
    v_and_b32 v7, 31, v3
    v_add_u32 v7, v7, v5
    v_lshl_add_u32 v6, v7, 4, v6
    v_add_u32 v6, s38, v6
    v_mov_b32 v7, 0x80000000
    v_cmp_gt_u32 vcc, 2048, v3
    s_mul_i32 s35, s25, 57344
    s_add_u32 s35, s35, s38
    s_add_u32 s35, s35, 23068672
    v_cndmask_b32 v4, v7, v6, vcc
    v_add_u32 v6, s35, v2
    v_add_u32 v7, 28672, v6
    s_setprio 0
    buffer_load_dwordx4 v[40:43], v4, s[12:15], s40 offen offset:0
    buffer_load_dwordx4 v[44:47], v6, s[20:23], s40 offen offset:0
    buffer_load_dwordx4 v[48:51], v7, s[20:23], s40 offen offset:0
    buffer_load_dwordx4 v[52:55], v4, s[12:15], s40 offen offset:1024
    buffer_load_dwordx4 v[56:59], v6, s[20:23], s40 offen offset:1024
    buffer_load_dwordx4 v[60:63], v7, s[20:23], s40 offen offset:1024
    buffer_load_dwordx4 v[64:67], v4, s[12:15], s40 offen offset:2048
    buffer_load_dwordx4 v[68:71], v6, s[20:23], s40 offen offset:2048
    buffer_load_dwordx4 v[72:75], v7, s[20:23], s40 offen offset:2048
    buffer_load_dwordx4 v[76:79], v4, s[12:15], s40 offen offset:3072
    buffer_load_dwordx4 v[80:83], v6, s[20:23], s40 offen offset:3072
    buffer_load_dwordx4 v[84:87], v7, s[20:23], s40 offen offset:3072
    buffer_load_dwordx4 v[88:91], v4, s[12:15], s41 offen offset:0
    buffer_load_dwordx4 v[92:95], v6, s[20:23], s41 offen offset:0
    buffer_load_dwordx4 v[96:99], v7, s[20:23], s41 offen offset:0
    buffer_load_dwordx4 v[100:103], v4, s[12:15], s41 offen offset:1024
    buffer_load_dwordx4 v[104:107], v6, s[20:23], s41 offen offset:1024
    buffer_load_dwordx4 v[108:111], v7, s[20:23], s41 offen offset:1024
    buffer_load_dwordx4 v[112:115], v4, s[12:15], s41 offen offset:2048
    buffer_load_dwordx4 v[116:119], v6, s[20:23], s41 offen offset:2048
    buffer_load_dwordx4 v[120:123], v7, s[20:23], s41 offen offset:2048
    s_setprio 3
    s_lshl_b32 s28, s25, 1
    s_add_u32 s28, s28, s46
    v_and_b32 v3, 31, v1
    s_lshl_b32 s35, s27, 5
    v_add_u32 v3, s35, v3
    v_mul_u32_u24 v3, 896, v3
    v_lshrrev_b32 v5, 5, v1
    v_lshl_add_u32 v3, v5, 3, v3
    s_lshl_b32 s39, s28, 6
    s_waitcnt vmcnt(18)
    v_mfma_f32_32x32x16_bf16 v[8:23], v[44:47], v[40:43], 0
    v_mfma_f32_32x32x16_bf16 v[24:39], v[48:51], v[40:43], 0
    s_waitcnt vmcnt(15)
    v_mfma_f32_32x32x16_bf16 v[8:23], v[56:59], v[52:55], v[8:23]
    v_mfma_f32_32x32x16_bf16 v[24:39], v[60:63], v[52:55], v[24:39]
    s_cmp_ge_u32 s46, 2
    s_cbranch_scc1 KM1_NOX
    buffer_load_dwordx2 v[40:41], v3, s[16:19], s39 offen offset:0
    buffer_load_dwordx2 v[42:43], v3, s[16:19], s39 offen offset:16
    buffer_load_dwordx2 v[44:45], v3, s[16:19], s39 offen offset:32
    buffer_load_dwordx2 v[46:47], v3, s[16:19], s39 offen offset:48
KM1_NOX:
    s_waitcnt vmcnt(12)
    v_mfma_f32_32x32x16_bf16 v[8:23], v[68:71], v[64:67], v[8:23]
    v_mfma_f32_32x32x16_bf16 v[24:39], v[72:75], v[64:67], v[24:39]
    s_waitcnt vmcnt(9)
    v_mfma_f32_32x32x16_bf16 v[8:23], v[80:83], v[76:79], v[8:23]
    v_mfma_f32_32x32x16_bf16 v[24:39], v[84:87], v[76:79], v[24:39]
    s_waitcnt vmcnt(6)
    v_mfma_f32_32x32x16_bf16 v[8:23], v[92:95], v[88:91], v[8:23]
    v_mfma_f32_32x32x16_bf16 v[24:39], v[96:99], v[88:91], v[24:39]
    s_waitcnt vmcnt(3)
    v_mfma_f32_32x32x16_bf16 v[8:23], v[104:107], v[100:103], v[8:23]
    v_mfma_f32_32x32x16_bf16 v[24:39], v[108:111], v[100:103], v[24:39]
    s_waitcnt vmcnt(0)
    v_mfma_f32_32x32x16_bf16 v[8:23], v[116:119], v[112:115], v[8:23]
    v_mfma_f32_32x32x16_bf16 v[24:39], v[120:123], v[112:115], v[24:39]
    s_lshl_b32 s35, s47, 15
    s_lshl_b32 s36, s46, 12
    s_add_u32 s36, s36, s35
    v_add_u32 v4, s36, v2
    s_lshl_b32 s36, s46, 14
    s_add_u32 s36, s36, s35
    v_add_u32 v5, s36, v2
    s_nop 7
    s_nop 7
    s_cmp_eq_u32 s46, 0
    s_cbranch_scc1 KM1_SK0
    ds_write_b128 v4, v[8:11] offset:0
    ds_write_b128 v4, v[12:15] offset:1024
    ds_write_b128 v4, v[16:19] offset:2048
    ds_write_b128 v4, v[20:23] offset:3072
KM1_SK0:
    s_cmp_eq_u32 s46, 1
    s_cbranch_scc1 KM1_SK1
    ds_write_b128 v4, v[24:27] offset:16384
    ds_write_b128 v4, v[28:31] offset:17408
    ds_write_b128 v4, v[32:35] offset:18432
    ds_write_b128 v4, v[36:39] offset:19456
KM1_SK1:
    s_waitcnt lgkmcnt(0)
    s_barrier
    s_cmp_ge_u32 s46, 2
    s_cbranch_scc1 KM1_FIN
    s_cmp_eq_u32 s46, 0
    s_cbranch_scc1 KM1_MV
    v_mov_b32 v8, v24
    v_mov_b32 v9, v25
    v_mov_b32 v10, v26
    v_mov_b32 v11, v27
    v_mov_b32 v12, v28
    v_mov_b32 v13, v29
    v_mov_b32 v14, v30
    v_mov_b32 v15, v31
    v_mov_b32 v16, v32
    v_mov_b32 v17, v33
    v_mov_b32 v18, v34
    v_mov_b32 v19, v35
    v_mov_b32 v20, v36
    v_mov_b32 v21, v37
    v_mov_b32 v22, v38
    v_mov_b32 v23, v39
KM1_MV:
    s_cmp_eq_u32 s46, 0
    s_cbranch_scc1 KM1_RD0
    ds_read_b128 v[64:67], v5 offset:0
    ds_read_b128 v[68:71], v5 offset:1024
    ds_read_b128 v[72:75], v5 offset:2048
    ds_read_b128 v[76:79], v5 offset:3072
    s_waitcnt lgkmcnt(0)
    v_add_f32 v8, v8, v64
    v_add_f32 v9, v9, v65
    v_add_f32 v10, v10, v66
    v_add_f32 v11, v11, v67
    v_add_f32 v12, v12, v68
    v_add_f32 v13, v13, v69
    v_add_f32 v14, v14, v70
    v_add_f32 v15, v15, v71
    v_add_f32 v16, v16, v72
    v_add_f32 v17, v17, v73
    v_add_f32 v18, v18, v74
    v_add_f32 v19, v19, v75
    v_add_f32 v20, v20, v76
    v_add_f32 v21, v21, v77
    v_add_f32 v22, v22, v78
    v_add_f32 v23, v23, v79
KM1_RD0:
    s_cmp_eq_u32 s46, 1
    s_cbranch_scc1 KM1_RD1
    ds_read_b128 v[64:67], v5 offset:4096
    ds_read_b128 v[68:71], v5 offset:5120
    ds_read_b128 v[72:75], v5 offset:6144
    ds_read_b128 v[76:79], v5 offset:7168
    s_waitcnt lgkmcnt(0)
    v_add_f32 v8, v8, v64
    v_add_f32 v9, v9, v65
    v_add_f32 v10, v10, v66
    v_add_f32 v11, v11, v67
    v_add_f32 v12, v12, v68
    v_add_f32 v13, v13, v69
    v_add_f32 v14, v14, v70
    v_add_f32 v15, v15, v71
    v_add_f32 v16, v16, v72
    v_add_f32 v17, v17, v73
    v_add_f32 v18, v18, v74
    v_add_f32 v19, v19, v75
    v_add_f32 v20, v20, v76
    v_add_f32 v21, v21, v77
    v_add_f32 v22, v22, v78
    v_add_f32 v23, v23, v79
KM1_RD1:
    s_cmp_eq_u32 s46, 2
    s_cbranch_scc1 KM1_RD2
    ds_read_b128 v[64:67], v5 offset:8192
    ds_read_b128 v[68:71], v5 offset:9216
    ds_read_b128 v[72:75], v5 offset:10240
    ds_read_b128 v[76:79], v5 offset:11264
    s_waitcnt lgkmcnt(0)
    v_add_f32 v8, v8, v64
    v_add_f32 v9, v9, v65
    v_add_f32 v10, v10, v66
    v_add_f32 v11, v11, v67
    v_add_f32 v12, v12, v68
    v_add_f32 v13, v13, v69
    v_add_f32 v14, v14, v70
    v_add_f32 v15, v15, v71
    v_add_f32 v16, v16, v72
    v_add_f32 v17, v17, v73
    v_add_f32 v18, v18, v74
    v_add_f32 v19, v19, v75
    v_add_f32 v20, v20, v76
    v_add_f32 v21, v21, v77
    v_add_f32 v22, v22, v78
    v_add_f32 v23, v23, v79
KM1_RD2:
    s_cmp_eq_u32 s46, 3
    s_cbranch_scc1 KM1_RD3
    ds_read_b128 v[64:67], v5 offset:12288
    ds_read_b128 v[68:71], v5 offset:13312
    ds_read_b128 v[72:75], v5 offset:14336
    ds_read_b128 v[76:79], v5 offset:15360
    s_waitcnt lgkmcnt(0)
    v_add_f32 v8, v8, v64
    v_add_f32 v9, v9, v65
    v_add_f32 v10, v10, v66
    v_add_f32 v11, v11, v67
    v_add_f32 v12, v12, v68
    v_add_f32 v13, v13, v69
    v_add_f32 v14, v14, v70
    v_add_f32 v15, v15, v71
    v_add_f32 v16, v16, v72
    v_add_f32 v17, v17, v73
    v_add_f32 v18, v18, v74
    v_add_f32 v19, v19, v75
    v_add_f32 v20, v20, v76
    v_add_f32 v21, v21, v77
    v_add_f32 v22, v22, v78
    v_add_f32 v23, v23, v79
KM1_RD3:
    v_mov_b32 v24, 0xffff0000
    v_mov_b32 v30, 0
    v_mov_b32 v31, 0
    s_mul_i32 s35, s27, 28672
    s_lshl_b32 s36, s28, 11
    s_add_u32 s35, s35, s36
    s_add_u32 s35, s35, 10485760
    s_waitcnt vmcnt(0)
    v_cvt_pk_bf16_f32 v25, v8, v9
    v_lshlrev_b32 v26, 16, v40
    v_and_b32 v27, v24, v40
    v_lshlrev_b32 v28, 16, v25
    v_and_b32 v29, v24, v25
    v_add_f32 v26, v26, v28
    v_add_f32 v27, v27, v29
    v_cvt_pk_bf16_f32 v64, v26, v27
    v_lshlrev_b32 v26, 16, v64
    v_and_b32 v27, v24, v64
    v_add_f32 v30, v30, v26
    v_fmac_f32 v31, v26, v26
    v_add_f32 v30, v30, v27
    v_fmac_f32 v31, v27, v27
    v_cvt_pk_bf16_f32 v25, v10, v11
    v_lshlrev_b32 v26, 16, v41
    v_and_b32 v27, v24, v41
    v_lshlrev_b32 v28, 16, v25
    v_and_b32 v29, v24, v25
    v_add_f32 v26, v26, v28
    v_add_f32 v27, v27, v29
    v_cvt_pk_bf16_f32 v65, v26, v27
    v_lshlrev_b32 v26, 16, v65
    v_and_b32 v27, v24, v65
    v_add_f32 v30, v30, v26
    v_fmac_f32 v31, v26, v26
    v_add_f32 v30, v30, v27
    v_fmac_f32 v31, v27, v27
    v_cvt_pk_bf16_f32 v25, v12, v13
    v_lshlrev_b32 v26, 16, v42
    v_and_b32 v27, v24, v42
    v_lshlrev_b32 v28, 16, v25
    v_and_b32 v29, v24, v25
    v_add_f32 v26, v26, v28
    v_add_f32 v27, v27, v29
    v_cvt_pk_bf16_f32 v66, v26, v27
    v_lshlrev_b32 v26, 16, v66
    v_and_b32 v27, v24, v66
    v_add_f32 v30, v30, v26
    v_fmac_f32 v31, v26, v26
    v_add_f32 v30, v30, v27
    v_fmac_f32 v31, v27, v27
    v_cvt_pk_bf16_f32 v25, v14, v15
    v_lshlrev_b32 v26, 16, v43
    v_and_b32 v27, v24, v43
    v_lshlrev_b32 v28, 16, v25
    v_and_b32 v29, v24, v25
    v_add_f32 v26, v26, v28
    v_add_f32 v27, v27, v29
    v_cvt_pk_bf16_f32 v67, v26, v27
    v_lshlrev_b32 v26, 16, v67
    v_and_b32 v27, v24, v67
    v_add_f32 v30, v30, v26
    v_fmac_f32 v31, v26, v26
    v_add_f32 v30, v30, v27
    v_fmac_f32 v31, v27, v27
    v_cvt_pk_bf16_f32 v25, v16, v17
    v_lshlrev_b32 v26, 16, v44
    v_and_b32 v27, v24, v44
    v_lshlrev_b32 v28, 16, v25
    v_and_b32 v29, v24, v25
    v_add_f32 v26, v26, v28
    v_add_f32 v27, v27, v29
    v_cvt_pk_bf16_f32 v68, v26, v27
    v_lshlrev_b32 v26, 16, v68
    v_and_b32 v27, v24, v68
    v_add_f32 v30, v30, v26
    v_fmac_f32 v31, v26, v26
    v_add_f32 v30, v30, v27
    v_fmac_f32 v31, v27, v27
    v_cvt_pk_bf16_f32 v25, v18, v19
    v_lshlrev_b32 v26, 16, v45
    v_and_b32 v27, v24, v45
    v_lshlrev_b32 v28, 16, v25
    v_and_b32 v29, v24, v25
    v_add_f32 v26, v26, v28
    v_add_f32 v27, v27, v29
    v_cvt_pk_bf16_f32 v69, v26, v27
    v_lshlrev_b32 v26, 16, v69
    v_and_b32 v27, v24, v69
    v_add_f32 v30, v30, v26
    v_fmac_f32 v31, v26, v26
    v_add_f32 v30, v30, v27
    v_fmac_f32 v31, v27, v27
    v_cvt_pk_bf16_f32 v25, v20, v21
    v_lshlrev_b32 v26, 16, v46
    v_and_b32 v27, v24, v46
    v_lshlrev_b32 v28, 16, v25
    v_and_b32 v29, v24, v25
    v_add_f32 v26, v26, v28
    v_add_f32 v27, v27, v29
    v_cvt_pk_bf16_f32 v70, v26, v27
    v_lshlrev_b32 v26, 16, v70
    v_and_b32 v27, v24, v70
    v_add_f32 v30, v30, v26
    v_fmac_f32 v31, v26, v26
    v_add_f32 v30, v30, v27
    v_fmac_f32 v31, v27, v27
    v_cvt_pk_bf16_f32 v25, v22, v23
    v_lshlrev_b32 v26, 16, v47
    v_and_b32 v27, v24, v47
    v_lshlrev_b32 v28, 16, v25
    v_and_b32 v29, v24, v25
    v_add_f32 v26, v26, v28
    v_add_f32 v27, v27, v29
    v_cvt_pk_bf16_f32 v71, v26, v27
    v_lshlrev_b32 v26, 16, v71
    v_and_b32 v27, v24, v71
    v_add_f32 v30, v30, v26
    v_fmac_f32 v31, v26, v26
    v_add_f32 v30, v30, v27
    v_fmac_f32 v31, v27, v27
    buffer_store_dwordx4 v[64:67], v2, s[20:23], s35 offen sc1
    buffer_store_dwordx4 v[68:71], v2, s[20:23], s35 offen offset:1024 sc1
    s_nop 1
    v_permlane32_swap_b32 v30, v31
    v_add_f32 v30, v30, v31
    v_lshlrev_b32 v3, 2, v1
    s_mul_i32 s35, s27, 3584
    s_lshl_b32 s36, s28, 8
    s_add_u32 s35, s35, s36
    s_add_u32 s35, s35, 31457280
    buffer_store_dword v30, v3, s[20:23], s35 offen sc1
KM1_FIN:
    s_lshr_b32 s29, s24, 1
    s_waitcnt vmcnt(0)
    s_barrier
    s_cmp_lg_u32 s26, 0
    s_cbranch_scc1 KM1_S
    s_lshl_b32 s35, s29, 8
    s_add_u32 s35, s35, 32505856
    v_mov_b32 v3, 0
    v_mov_b32 v4, 1
    s_mov_b64 s[36:37], exec
    s_mov_b64 exec, 1
    buffer_atomic_add v4, v3, s[20:23], s35 offen sc1
    s_mov_b64 exec, s[36:37]
KM1_S:
    s_and_b32 s24, s2, 15
    s_lshr_b32 s25, s2, 4
    s_and_b32 s52, s26, 1
    s_lshr_b32 s53, s26, 1
    s_lshl_b32 s32, s26, 11
    s_lshl_b32 s35, s24, 2
    s_add_u32 s35, s35, s26
    s_mul_i32 s30, s35, 28672
    s_add_u32 s30, s30, 10485760
    s_lshl_b32 s35, s25, 2
    s_add_u32 s35, s35, s26
    s_sub_u32 s35, s35, 4
    s_mul_i32 s31, s35, 28672
    s_add_u32 s31, s31, 24117248
    s_cmp_lt_u32 s26, 4
    s_cselect_b32 s30, s30, s31
    s_lshl_b32 s27, s24, 2
    s_lshl_b32 s35, s52, 1
    s_add_u32 s27, s27, s35
    s_lshl_b32 s28, s25, 2
    s_add_u32 s28, s28, s53
    s_lshl_b32 s35, s52, 12
    v_add_u32 v10, s35, v2
    s_lshl_b32 s35, s53, 11
    s_add_u32 s35, s35, 8192
    v_add_u32 v11, s35, v2
    v_add_u32 v12, 0x10000, v10
    v_add_u32 v13, 0x10000, v11
    s_mov_b32 s29, s24
    s_cmp_lg_u32 s26, 0
    s_cbranch_scc1 KM2_D
    s_setprio 0
    s_lshl_b32 s36, s29, 8
    s_add_u32 s36, s36, 32505856
    v_mov_b32 v4, 0
KM2_P:
    buffer_load_dword v5, v4, s[20:23], s36 offen sc1
    s_waitcnt vmcnt(0)
    v_readfirstlane_b32 s35, v5
    s_cmp_ge_u32 s35, 14
    s_cbranch_scc1 KM2_D
    s_sleep 2
    s_branch KM2_P
KM2_D:
    s_barrier
    s_setprio 3
    s_add_u32 m0, s32, 0
    s_add_u32 s33, s30, 0
    s_setprio 0
    buffer_load_dwordx4 v2, s[20:23], s33 offen lds
    buffer_load_dwordx4 v2, s[20:23], s33 offen offset:1024 lds
    s_setprio 3
    s_add_u32 m0, s32, 16384
    s_add_u32 s33, s30, 2048
    s_setprio 0
    buffer_load_dwordx4 v2, s[20:23], s33 offen lds
    buffer_load_dwordx4 v2, s[20:23], s33 offen offset:1024 lds
    s_setprio 3
    s_add_u32 m0, s32, 32768
    s_add_u32 s33, s30, 4096
    s_setprio 0
    buffer_load_dwordx4 v2, s[20:23], s33 offen lds
    buffer_load_dwordx4 v2, s[20:23], s33 offen offset:1024 lds
    s_setprio 3
    s_add_u32 m0, s32, 49152
    s_add_u32 s33, s30, 6144
    s_setprio 0
    buffer_load_dwordx4 v2, s[20:23], s33 offen lds
    buffer_load_dwordx4 v2, s[20:23], s33 offen offset:1024 lds
    s_setprio 3
    v_lshlrev_b32 v3, 2, v1
    s_mul_i32 s38, s27, 3584
    s_add_u32 s38, s38, 31457280
    s_add_u32 s37, s38, 3584
    s_mul_i32 s39, s28, 3584
    s_add_u32 s39, s39, 30408704
    v_and_b32 v8, 31, v1
    v_lshlrev_b32 v8, 2, v8
    s_lshl_b32 s35, s27, 7
    s_add_u32 s35, s35, 29360128
    buffer_load_dword v20, v8, s[20:23], s35 offen
    buffer_load_dword v21, v8, s[20:23], s35 offen offset:128
    s_setprio 0
    buffer_load_dword v64, v3, s[20:23], s38 offen offset:0
    buffer_load_dword v65, v3, s[20:23], s38 offen offset:256
    buffer_load_dword v66, v3, s[20:23], s38 offen offset:512
    buffer_load_dword v67, v3, s[20:23], s38 offen offset:768
    buffer_load_dword v68, v3, s[20:23], s38 offen offset:1024
    buffer_load_dword v69, v3, s[20:23], s38 offen offset:1280
    buffer_load_dword v70, v3, s[20:23], s38 offen offset:1536
    buffer_load_dword v71, v3, s[20:23], s38 offen offset:1792
    buffer_load_dword v72, v3, s[20:23], s38 offen offset:2048
    buffer_load_dword v73, v3, s[20:23], s38 offen offset:2304
    buffer_load_dword v74, v3, s[20:23], s38 offen offset:2560
    buffer_load_dword v75, v3, s[20:23], s38 offen offset:2816
    buffer_load_dword v76, v3, s[20:23], s38 offen offset:3072
    buffer_load_dword v77, v3, s[20:23], s38 offen offset:3328
    buffer_load_dword v78, v3, s[20:23], s37 offen offset:0
    buffer_load_dword v79, v3, s[20:23], s37 offen offset:256
    buffer_load_dword v80, v3, s[20:23], s37 offen offset:512
    buffer_load_dword v81, v3, s[20:23], s37 offen offset:768
    buffer_load_dword v82, v3, s[20:23], s37 offen offset:1024
    buffer_load_dword v83, v3, s[20:23], s37 offen offset:1280
    buffer_load_dword v84, v3, s[20:23], s37 offen offset:1536
    buffer_load_dword v85, v3, s[20:23], s37 offen offset:1792
    buffer_load_dword v86, v3, s[20:23], s37 offen offset:2048
    buffer_load_dword v87, v3, s[20:23], s37 offen offset:2304
    buffer_load_dword v88, v3, s[20:23], s37 offen offset:2560
    buffer_load_dword v89, v3, s[20:23], s37 offen offset:2816
    buffer_load_dword v90, v3, s[20:23], s37 offen offset:3072
    buffer_load_dword v91, v3, s[20:23], s37 offen offset:3328
    buffer_load_dword v92, v3, s[20:23], s39 offen offset:0
    buffer_load_dword v93, v3, s[20:23], s39 offen offset:256
    buffer_load_dword v94, v3, s[20:23], s39 offen offset:512
    buffer_load_dword v95, v3, s[20:23], s39 offen offset:768
    buffer_load_dword v96, v3, s[20:23], s39 offen offset:1024
    buffer_load_dword v97, v3, s[20:23], s39 offen offset:1280
    buffer_load_dword v98, v3, s[20:23], s39 offen offset:1536
    buffer_load_dword v99, v3, s[20:23], s39 offen offset:1792
    buffer_load_dword v100, v3, s[20:23], s39 offen offset:2048
    buffer_load_dword v101, v3, s[20:23], s39 offen offset:2304
    buffer_load_dword v102, v3, s[20:23], s39 offen offset:2560
    buffer_load_dword v103, v3, s[20:23], s39 offen offset:2816
    buffer_load_dword v104, v3, s[20:23], s39 offen offset:3072
    buffer_load_dword v105, v3, s[20:23], s39 offen offset:3328
    s_setprio 3
    s_waitcnt vmcnt(50)
    s_barrier
    ds_read_b128 v[24:27], v10 offset:0
    ds_read_b128 v[28:31], v10 offset:2048
    ds_read_b128 v[32:35], v11 offset:0
    ds_read_b128 v[36:39], v10 offset:1024
    ds_read_b128 v[40:43], v10 offset:3072
    ds_read_b128 v[44:47], v11 offset:1024
    s_waitcnt lgkmcnt(3)
    v_mfma_f32_32x32x16_bf16 v[48:63], v[32:35], v[24:27], 0
    v_mfma_f32_32x32x16_bf16 v[112:127], v[32:35], v[28:31], 0
    s_waitcnt vmcnt(48)
    s_barrier
    s_add_u32 m0, s32, 65536
    s_add_u32 s33, s30, 8192
    s_setprio 0
    buffer_load_dwordx4 v2, s[20:23], s33 offen lds
    buffer_load_dwordx4 v2, s[20:23], s33 offen offset:1024 lds
    s_setprio 3
    ds_read_b128 v[24:27], v10 offset:16384
    ds_read_b128 v[28:31], v10 offset:18432
    ds_read_b128 v[32:35], v11 offset:16384
    s_waitcnt lgkmcnt(3)
    v_mfma_f32_32x32x16_bf16 v[48:63], v[44:47], v[36:39], v[48:63]
    v_mfma_f32_32x32x16_bf16 v[112:127], v[44:47], v[40:43], v[112:127]
    ds_read_b128 v[36:39], v10 offset:17408
    ds_read_b128 v[40:43], v10 offset:19456
    ds_read_b128 v[44:47], v11 offset:17408
    s_waitcnt lgkmcnt(3)
    v_mfma_f32_32x32x16_bf16 v[48:63], v[32:35], v[24:27], v[48:63]
    v_mfma_f32_32x32x16_bf16 v[112:127], v[32:35], v[28:31], v[112:127]
    s_waitcnt vmcnt(48)
    s_barrier
    s_add_u32 m0, s32, 0
    s_add_u32 s33, s30, 10240
    s_setprio 0
    buffer_load_dwordx4 v2, s[20:23], s33 offen lds
    buffer_load_dwordx4 v2, s[20:23], s33 offen offset:1024 lds
    s_setprio 3
    ds_read_b128 v[24:27], v10 offset:32768
    ds_read_b128 v[28:31], v10 offset:34816
    ds_read_b128 v[32:35], v11 offset:32768
    s_waitcnt lgkmcnt(3)
    v_mfma_f32_32x32x16_bf16 v[48:63], v[44:47], v[36:39], v[48:63]
    v_mfma_f32_32x32x16_bf16 v[112:127], v[44:47], v[40:43], v[112:127]
    ds_read_b128 v[36:39], v10 offset:33792
    ds_read_b128 v[40:43], v10 offset:35840
    ds_read_b128 v[44:47], v11 offset:33792
    s_waitcnt lgkmcnt(3)
    v_mfma_f32_32x32x16_bf16 v[48:63], v[32:35], v[24:27], v[48:63]
    v_mfma_f32_32x32x16_bf16 v[112:127], v[32:35], v[28:31], v[112:127]
    s_waitcnt vmcnt(48)
    s_barrier
    s_add_u32 m0, s32, 16384
    s_add_u32 s33, s30, 12288
    s_setprio 0
    buffer_load_dwordx4 v2, s[20:23], s33 offen lds
    buffer_load_dwordx4 v2, s[20:23], s33 offen offset:1024 lds
    s_setprio 3
    ds_read_b128 v[24:27], v10 offset:49152
    ds_read_b128 v[28:31], v10 offset:51200
    ds_read_b128 v[32:35], v11 offset:49152
    s_waitcnt lgkmcnt(3)
    v_mfma_f32_32x32x16_bf16 v[48:63], v[44:47], v[36:39], v[48:63]
    v_mfma_f32_32x32x16_bf16 v[112:127], v[44:47], v[40:43], v[112:127]
    ds_read_b128 v[36:39], v10 offset:50176
    ds_read_b128 v[40:43], v10 offset:52224
    ds_read_b128 v[44:47], v11 offset:50176
    s_waitcnt lgkmcnt(3)
    v_mfma_f32_32x32x16_bf16 v[48:63], v[32:35], v[24:27], v[48:63]
    v_mfma_f32_32x32x16_bf16 v[112:127], v[32:35], v[28:31], v[112:127]
    s_waitcnt vmcnt(4)
    s_barrier
    s_add_u32 m0, s32, 32768
    s_add_u32 s33, s30, 14336
    s_setprio 0
    buffer_load_dwordx4 v2, s[20:23], s33 offen lds
    buffer_load_dwordx4 v2, s[20:23], s33 offen offset:1024 lds
    s_setprio 3
    ds_read_b128 v[24:27], v12 offset:0
    ds_read_b128 v[28:31], v12 offset:2048
    ds_read_b128 v[32:35], v13 offset:0
    s_waitcnt lgkmcnt(3)
    v_mfma_f32_32x32x16_bf16 v[48:63], v[44:47], v[36:39], v[48:63]
    v_mfma_f32_32x32x16_bf16 v[112:127], v[44:47], v[40:43], v[112:127]
    ds_read_b128 v[36:39], v12 offset:1024
    ds_read_b128 v[40:43], v12 offset:3072
    ds_read_b128 v[44:47], v13 offset:1024
    s_waitcnt lgkmcnt(3)
    v_mfma_f32_32x32x16_bf16 v[48:63], v[32:35], v[24:27], v[48:63]
    v_mfma_f32_32x32x16_bf16 v[112:127], v[32:35], v[28:31], v[112:127]
    s_waitcnt vmcnt(4)
    s_barrier
    s_add_u32 m0, s32, 49152
    s_add_u32 s33, s30, 16384
    s_setprio 0
    buffer_load_dwordx4 v2, s[20:23], s33 offen lds
    buffer_load_dwordx4 v2, s[20:23], s33 offen offset:1024 lds
    s_setprio 3
    ds_read_b128 v[24:27], v10 offset:0
    ds_read_b128 v[28:31], v10 offset:2048
    ds_read_b128 v[32:35], v11 offset:0
    s_waitcnt lgkmcnt(3)
    v_mfma_f32_32x32x16_bf16 v[48:63], v[44:47], v[36:39], v[48:63]
    v_mfma_f32_32x32x16_bf16 v[112:127], v[44:47], v[40:43], v[112:127]
    ds_read_b128 v[36:39], v10 offset:1024
    ds_read_b128 v[40:43], v10 offset:3072
    ds_read_b128 v[44:47], v11 offset:1024
    s_waitcnt lgkmcnt(3)
    v_mfma_f32_32x32x16_bf16 v[48:63], v[32:35], v[24:27], v[48:63]
    v_mfma_f32_32x32x16_bf16 v[112:127], v[32:35], v[28:31], v[112:127]
    s_waitcnt vmcnt(4)
    s_barrier
    s_add_u32 m0, s32, 65536
    s_add_u32 s33, s30, 18432
    s_setprio 0
    buffer_load_dwordx4 v2, s[20:23], s33 offen lds
    buffer_load_dwordx4 v2, s[20:23], s33 offen offset:1024 lds
    s_setprio 3
    ds_read_b128 v[24:27], v10 offset:16384
    ds_read_b128 v[28:31], v10 offset:18432
    ds_read_b128 v[32:35], v11 offset:16384
    s_waitcnt lgkmcnt(3)
    v_mfma_f32_32x32x16_bf16 v[48:63], v[44:47], v[36:39], v[48:63]
    v_mfma_f32_32x32x16_bf16 v[112:127], v[44:47], v[40:43], v[112:127]
    ds_read_b128 v[36:39], v10 offset:17408
    ds_read_b128 v[40:43], v10 offset:19456
    ds_read_b128 v[44:47], v11 offset:17408
    s_waitcnt lgkmcnt(3)
    v_mfma_f32_32x32x16_bf16 v[48:63], v[32:35], v[24:27], v[48:63]
    v_mfma_f32_32x32x16_bf16 v[112:127], v[32:35], v[28:31], v[112:127]
    s_waitcnt vmcnt(4)
    s_barrier
    s_add_u32 m0, s32, 0
    s_add_u32 s33, s30, 20480
    s_setprio 0
    buffer_load_dwordx4 v2, s[20:23], s33 offen lds
    buffer_load_dwordx4 v2, s[20:23], s33 offen offset:1024 lds
    s_setprio 3
    ds_read_b128 v[24:27], v10 offset:32768
    ds_read_b128 v[28:31], v10 offset:34816
    ds_read_b128 v[32:35], v11 offset:32768
    s_waitcnt lgkmcnt(3)
    v_mfma_f32_32x32x16_bf16 v[48:63], v[44:47], v[36:39], v[48:63]
    v_mfma_f32_32x32x16_bf16 v[112:127], v[44:47], v[40:43], v[112:127]
    ds_read_b128 v[36:39], v10 offset:33792
    ds_read_b128 v[40:43], v10 offset:35840
    ds_read_b128 v[44:47], v11 offset:33792
    s_waitcnt lgkmcnt(3)
    v_mfma_f32_32x32x16_bf16 v[48:63], v[32:35], v[24:27], v[48:63]
    v_mfma_f32_32x32x16_bf16 v[112:127], v[32:35], v[28:31], v[112:127]
    s_waitcnt vmcnt(4)
    s_barrier
    s_add_u32 m0, s32, 16384
    s_add_u32 s33, s30, 22528
    s_setprio 0
    buffer_load_dwordx4 v2, s[20:23], s33 offen lds
    buffer_load_dwordx4 v2, s[20:23], s33 offen offset:1024 lds
    s_setprio 3
    ds_read_b128 v[24:27], v10 offset:49152
    ds_read_b128 v[28:31], v10 offset:51200
    ds_read_b128 v[32:35], v11 offset:49152
    s_waitcnt lgkmcnt(3)
    v_mfma_f32_32x32x16_bf16 v[48:63], v[44:47], v[36:39], v[48:63]
    v_mfma_f32_32x32x16_bf16 v[112:127], v[44:47], v[40:43], v[112:127]
    ds_read_b128 v[36:39], v10 offset:50176
    ds_read_b128 v[40:43], v10 offset:52224
    ds_read_b128 v[44:47], v11 offset:50176
    s_waitcnt lgkmcnt(3)
    v_mfma_f32_32x32x16_bf16 v[48:63], v[32:35], v[24:27], v[48:63]
    v_mfma_f32_32x32x16_bf16 v[112:127], v[32:35], v[28:31], v[112:127]
    s_waitcnt vmcnt(4)
    s_barrier
    s_add_u32 m0, s32, 32768
    s_add_u32 s33, s30, 24576
    s_setprio 0
    buffer_load_dwordx4 v2, s[20:23], s33 offen lds
    buffer_load_dwordx4 v2, s[20:23], s33 offen offset:1024 lds
    s_setprio 3
    ds_read_b128 v[24:27], v12 offset:0
    ds_read_b128 v[28:31], v12 offset:2048
    ds_read_b128 v[32:35], v13 offset:0
    s_waitcnt lgkmcnt(3)
    v_mfma_f32_32x32x16_bf16 v[48:63], v[44:47], v[36:39], v[48:63]
    v_mfma_f32_32x32x16_bf16 v[112:127], v[44:47], v[40:43], v[112:127]
    ds_read_b128 v[36:39], v12 offset:1024
    ds_read_b128 v[40:43], v12 offset:3072
    ds_read_b128 v[44:47], v13 offset:1024
    s_waitcnt lgkmcnt(3)
    v_mfma_f32_32x32x16_bf16 v[48:63], v[32:35], v[24:27], v[48:63]
    v_mfma_f32_32x32x16_bf16 v[112:127], v[32:35], v[28:31], v[112:127]
    s_waitcnt vmcnt(4)
    s_barrier
    s_add_u32 m0, s32, 49152
    s_add_u32 s33, s30, 26624
    s_setprio 0
    buffer_load_dwordx4 v2, s[20:23], s33 offen lds
    buffer_load_dwordx4 v2, s[20:23], s33 offen offset:1024 lds
    s_setprio 3
    ds_read_b128 v[24:27], v10 offset:0
    ds_read_b128 v[28:31], v10 offset:2048
    ds_read_b128 v[32:35], v11 offset:0
    s_waitcnt lgkmcnt(3)
    v_mfma_f32_32x32x16_bf16 v[48:63], v[44:47], v[36:39], v[48:63]
    v_mfma_f32_32x32x16_bf16 v[112:127], v[44:47], v[40:43], v[112:127]
    ds_read_b128 v[36:39], v10 offset:1024
    ds_read_b128 v[40:43], v10 offset:3072
    ds_read_b128 v[44:47], v11 offset:1024
    s_waitcnt lgkmcnt(3)
    v_mfma_f32_32x32x16_bf16 v[48:63], v[32:35], v[24:27], v[48:63]
    v_mfma_f32_32x32x16_bf16 v[112:127], v[32:35], v[28:31], v[112:127]
    s_waitcnt vmcnt(4)
    s_barrier
    ds_read_b128 v[24:27], v10 offset:16384
    ds_read_b128 v[28:31], v10 offset:18432
    ds_read_b128 v[32:35], v11 offset:16384
    s_waitcnt lgkmcnt(3)
    v_mfma_f32_32x32x16_bf16 v[48:63], v[44:47], v[36:39], v[48:63]
    v_mfma_f32_32x32x16_bf16 v[112:127], v[44:47], v[40:43], v[112:127]
    ds_read_b128 v[36:39], v10 offset:17408
    ds_read_b128 v[40:43], v10 offset:19456
    ds_read_b128 v[44:47], v11 offset:17408
    s_waitcnt lgkmcnt(3)
    v_mfma_f32_32x32x16_bf16 v[48:63], v[32:35], v[24:27], v[48:63]
    v_mfma_f32_32x32x16_bf16 v[112:127], v[32:35], v[28:31], v[112:127]
    s_waitcnt vmcnt(2)
    s_barrier
    ds_read_b128 v[24:27], v10 offset:32768
    ds_read_b128 v[28:31], v10 offset:34816
    ds_read_b128 v[32:35], v11 offset:32768
    s_waitcnt lgkmcnt(3)
    v_mfma_f32_32x32x16_bf16 v[48:63], v[44:47], v[36:39], v[48:63]
    v_mfma_f32_32x32x16_bf16 v[112:127], v[44:47], v[40:43], v[112:127]
    ds_read_b128 v[36:39], v10 offset:33792
    ds_read_b128 v[40:43], v10 offset:35840
    ds_read_b128 v[44:47], v11 offset:33792
    s_waitcnt lgkmcnt(3)
    v_mfma_f32_32x32x16_bf16 v[48:63], v[32:35], v[24:27], v[48:63]
    v_mfma_f32_32x32x16_bf16 v[112:127], v[32:35], v[28:31], v[112:127]
    s_waitcnt vmcnt(0)
    s_barrier
    ds_read_b128 v[24:27], v10 offset:49152
    ds_read_b128 v[28:31], v10 offset:51200
    ds_read_b128 v[32:35], v11 offset:49152
    s_waitcnt lgkmcnt(3)
    v_mfma_f32_32x32x16_bf16 v[48:63], v[44:47], v[36:39], v[48:63]
    v_mfma_f32_32x32x16_bf16 v[112:127], v[44:47], v[40:43], v[112:127]
    ds_read_b128 v[36:39], v10 offset:50176
    ds_read_b128 v[40:43], v10 offset:52224
    ds_read_b128 v[44:47], v11 offset:50176
    s_waitcnt lgkmcnt(3)
    v_mfma_f32_32x32x16_bf16 v[48:63], v[32:35], v[24:27], v[48:63]
    v_mfma_f32_32x32x16_bf16 v[112:127], v[32:35], v[28:31], v[112:127]
    s_waitcnt lgkmcnt(0)
    v_mfma_f32_32x32x16_bf16 v[48:63], v[44:47], v[36:39], v[48:63]
    v_mfma_f32_32x32x16_bf16 v[112:127], v[44:47], v[40:43], v[112:127]
    s_waitcnt vmcnt(0)
    v_add_f32 v8, v64, v65
    v_add_f32 v8, v8, v66
    v_add_f32 v8, v8, v67
    v_add_f32 v8, v8, v68
    v_add_f32 v8, v8, v69
    v_add_f32 v8, v8, v70
    v_add_f32 v8, v8, v71
    v_add_f32 v8, v8, v72
    v_add_f32 v8, v8, v73
    v_add_f32 v8, v8, v74
    v_add_f32 v8, v8, v75
    v_add_f32 v8, v8, v76
    v_add_f32 v8, v8, v77
    v_add_f32 v9, v78, v79
    v_add_f32 v9, v9, v80
    v_add_f32 v9, v9, v81
    v_add_f32 v9, v9, v82
    v_add_f32 v9, v9, v83
    v_add_f32 v9, v9, v84
    v_add_f32 v9, v9, v85
    v_add_f32 v9, v9, v86
    v_add_f32 v9, v9, v87
    v_add_f32 v9, v9, v88
    v_add_f32 v9, v9, v89
    v_add_f32 v9, v9, v90
    v_add_f32 v9, v9, v91
    v_add_f32 v10, v92, v93
    v_add_f32 v10, v10, v94
    v_add_f32 v10, v10, v95
    v_add_f32 v10, v10, v96
    v_add_f32 v10, v10, v97
    v_add_f32 v10, v10, v98
    v_add_f32 v10, v10, v99
    v_add_f32 v10, v10, v100
    v_add_f32 v10, v10, v101
    v_add_f32 v10, v10, v102
    v_add_f32 v10, v10, v103
    v_add_f32 v10, v10, v104
    v_add_f32 v10, v10, v105
    v_mov_b32 v12, v8
    v_mov_b32 v13, v9
    v_mov_b32 v14, v10
    s_nop 1
    v_permlane32_swap_b32 v8, v12
    v_permlane32_swap_b32 v9, v13
    v_permlane32_swap_b32 v10, v14
    v_add_f32 v10, v10, v14
    v_and_b32 v3, 31, v1
    v_lshlrev_b32 v3, 2, v3
    s_lshl_b32 s35, s26, 7
    s_add_u32 s35, s35, 16384
    v_add_u32 v3, s35, v3
    ds_write_b32 v3, v10
    v_lshrrev_b32 v3, 5, v1
    v_lshlrev_b32 v3, 4, v3
    v_add_u32 v3, s35, v3
    v_mul_f32 v8, 0x3b124925, v8
    v_mul_f32 v9, 0x3b124925, v9
    v_mul_f32 v12, 0x3b124925, v12
    v_mul_f32 v13, 0x3b124925, v13
    v_fma_f32 v12, -v8, v8, v12
    v_fma_f32 v13, -v9, v9, v13
    v_max_f32 v12, 0, v12
    v_max_f32 v13, 0, v13
    v_add_f32 v12, 0x3727c5ac, v12
    v_add_f32 v13, 0x3727c5ac, v13
    v_rsq_f32 v12, v12
    v_rsq_f32 v13, v13
    v_sub_f32 v20, 1.0, v20
    v_sub_f32 v21, 1.0, v21
    s_waitcnt lgkmcnt(0)
    ds_read_b128 v[64:67], v3 offset:0
    ds_read_b128 v[68:71], v3 offset:32
    ds_read_b128 v[72:75], v3 offset:64
    ds_read_b128 v[76:79], v3 offset:96
    v_mov_b32 v16, 0xbdd2d3e8
    v_mov_b32 v17, 0xbdd2d3e8
    v_mov_b32 v18, 0xc0135761
    v_mov_b32 v19, 0xc0135761
    s_mul_i32 s49, s27, 114688
    s_lshl_b32 s35, s28, 11
    s_add_u32 s49, s49, s35
    s_add_u32 s49, s49, 12582912
    s_waitcnt lgkmcnt(0)
    v_fma_f32 v48, -v8, v64, v48
    v_fma_f32 v49, -v8, v65, v49
    v_fma_f32 v50, -v8, v66, v50
    v_fma_f32 v51, -v8, v67, v51
    v_fma_f32 v52, -v8, v68, v52
    v_fma_f32 v53, -v8, v69, v53
    v_fma_f32 v54, -v8, v70, v54
    v_fma_f32 v55, -v8, v71, v55
    v_fma_f32 v56, -v8, v72, v56
    v_fma_f32 v57, -v8, v73, v57
    v_fma_f32 v58, -v8, v74, v58
    v_fma_f32 v59, -v8, v75, v59
    v_fma_f32 v60, -v8, v76, v60
    v_fma_f32 v61, -v8, v77, v61
    v_fma_f32 v62, -v8, v78, v62
    v_fma_f32 v63, -v8, v79, v63
    v_mul_f32 v48, v12, v48
    v_mul_f32 v49, v12, v49
    v_mul_f32 v50, v12, v50
    v_mul_f32 v51, v12, v51
    v_mul_f32 v52, v12, v52
    v_mul_f32 v53, v12, v53
    v_mul_f32 v54, v12, v54
    v_mul_f32 v55, v12, v55
    v_mul_f32 v56, v12, v56
    v_mul_f32 v57, v12, v57
    v_mul_f32 v58, v12, v58
    v_mul_f32 v59, v12, v59
    v_mul_f32 v60, v12, v60
    v_mul_f32 v61, v12, v61
    v_mul_f32 v62, v12, v62
    v_mul_f32 v63, v12, v63
    v_pk_mul_f32 v[80:81], v[48:49], v[48:49]
    v_pk_mul_f32 v[82:83], v[50:51], v[50:51]
    v_pk_mul_f32 v[84:85], v[52:53], v[52:53]
    v_pk_mul_f32 v[86:87], v[54:55], v[54:55]
    v_pk_mul_f32 v[88:89], v[56:57], v[56:57]
    v_pk_mul_f32 v[90:91], v[58:59], v[58:59]
    v_pk_mul_f32 v[92:93], v[60:61], v[60:61]
    v_pk_mul_f32 v[94:95], v[62:63], v[62:63]
    v_pk_fma_f32 v[80:81], v[80:81], v[16:17], v[18:19]
    v_pk_fma_f32 v[82:83], v[82:83], v[16:17], v[18:19]
    v_pk_fma_f32 v[84:85], v[84:85], v[16:17], v[18:19]
    v_pk_fma_f32 v[86:87], v[86:87], v[16:17], v[18:19]
    v_pk_fma_f32 v[88:89], v[88:89], v[16:17], v[18:19]
    v_pk_fma_f32 v[90:91], v[90:91], v[16:17], v[18:19]
    v_pk_fma_f32 v[92:93], v[92:93], v[16:17], v[18:19]
    v_pk_fma_f32 v[94:95], v[94:95], v[16:17], v[18:19]
    v_pk_mul_f32 v[80:81], v[80:81], v[48:49]
    v_pk_mul_f32 v[82:83], v[82:83], v[50:51]
    v_pk_mul_f32 v[84:85], v[84:85], v[52:53]
    v_pk_mul_f32 v[86:87], v[86:87], v[54:55]
    v_pk_mul_f32 v[88:89], v[88:89], v[56:57]
    v_pk_mul_f32 v[90:91], v[90:91], v[58:59]
    v_pk_mul_f32 v[92:93], v[92:93], v[60:61]
    v_pk_mul_f32 v[94:95], v[94:95], v[62:63]
    v_exp_f32 v80, v80
    v_exp_f32 v81, v81
    v_exp_f32 v82, v82
    v_exp_f32 v83, v83
    v_exp_f32 v84, v84
    v_exp_f32 v85, v85
    v_exp_f32 v86, v86
    v_exp_f32 v87, v87
    v_exp_f32 v88, v88
    v_exp_f32 v89, v89
    v_exp_f32 v90, v90
    v_exp_f32 v91, v91
    v_exp_f32 v92, v92
    v_exp_f32 v93, v93
    v_exp_f32 v94, v94
    v_exp_f32 v95, v95
    v_pk_add_f32 v[80:81], v[80:81], 1.0 op_sel_hi:[1,0]
    v_pk_add_f32 v[82:83], v[82:83], 1.0 op_sel_hi:[1,0]
    v_pk_add_f32 v[84:85], v[84:85], 1.0 op_sel_hi:[1,0]
    v_pk_add_f32 v[86:87], v[86:87], 1.0 op_sel_hi:[1,0]
    v_pk_add_f32 v[88:89], v[88:89], 1.0 op_sel_hi:[1,0]
    v_pk_add_f32 v[90:91], v[90:91], 1.0 op_sel_hi:[1,0]
    v_pk_add_f32 v[92:93], v[92:93], 1.0 op_sel_hi:[1,0]
    v_pk_add_f32 v[94:95], v[94:95], 1.0 op_sel_hi:[1,0]
    v_rcp_f32 v80, v80
    v_rcp_f32 v81, v81
    v_rcp_f32 v82, v82
    v_rcp_f32 v83, v83
    v_rcp_f32 v84, v84
    v_rcp_f32 v85, v85
    v_rcp_f32 v86, v86
    v_rcp_f32 v87, v87
    v_rcp_f32 v88, v88
    v_rcp_f32 v89, v89
    v_rcp_f32 v90, v90
    v_rcp_f32 v91, v91
    v_rcp_f32 v92, v92
    v_rcp_f32 v93, v93
    v_rcp_f32 v94, v94
    v_rcp_f32 v95, v95
    v_pk_mul_f32 v[48:49], v[48:49], v[80:81]
    v_pk_mul_f32 v[50:51], v[50:51], v[82:83]
    v_pk_mul_f32 v[52:53], v[52:53], v[84:85]
    v_pk_mul_f32 v[54:55], v[54:55], v[86:87]
    v_pk_mul_f32 v[56:57], v[56:57], v[88:89]
    v_pk_mul_f32 v[58:59], v[58:59], v[90:91]
    v_pk_mul_f32 v[60:61], v[60:61], v[92:93]
    v_pk_mul_f32 v[62:63], v[62:63], v[94:95]
    v_mul_f32 v48, v20, v48
    v_mul_f32 v49, v20, v49
    v_mul_f32 v50, v20, v50
    v_mul_f32 v51, v20, v51
    v_mul_f32 v52, v20, v52
    v_mul_f32 v53, v20, v53
    v_mul_f32 v54, v20, v54
    v_mul_f32 v55, v20, v55
    v_mul_f32 v56, v20, v56
    v_mul_f32 v57, v20, v57
    v_mul_f32 v58, v20, v58
    v_mul_f32 v59, v20, v59
    v_mul_f32 v60, v20, v60
    v_mul_f32 v61, v20, v61
    v_mul_f32 v62, v20, v62
    v_mul_f32 v63, v20, v63
    v_cvt_pk_bf16_f32 v24, v48, v49
    v_cvt_pk_bf16_f32 v25, v50, v51
    v_cvt_pk_bf16_f32 v26, v52, v53
    v_cvt_pk_bf16_f32 v27, v54, v55
    v_cvt_pk_bf16_f32 v28, v56, v57
    v_cvt_pk_bf16_f32 v29, v58, v59
    v_cvt_pk_bf16_f32 v30, v60, v61
    v_cvt_pk_bf16_f32 v31, v62, v63
    s_add_u32 s50, s49, 0
    buffer_store_dwordx4 v[24:27], v2, s[20:23], s50 offen sc1
    buffer_store_dwordx4 v[28:31], v2, s[20:23], s50 offen offset:1024 sc1
    s_nop 1
    v_fma_f32 v112, -v9, v64, v112
    v_fma_f32 v113, -v9, v65, v113
    v_fma_f32 v114, -v9, v66, v114
    v_fma_f32 v115, -v9, v67, v115
    v_fma_f32 v116, -v9, v68, v116
    v_fma_f32 v117, -v9, v69, v117
    v_fma_f32 v118, -v9, v70, v118
    v_fma_f32 v119, -v9, v71, v119
    v_fma_f32 v120, -v9, v72, v120
    v_fma_f32 v121, -v9, v73, v121
    v_fma_f32 v122, -v9, v74, v122
    v_fma_f32 v123, -v9, v75, v123
    v_fma_f32 v124, -v9, v76, v124
    v_fma_f32 v125, -v9, v77, v125
    v_fma_f32 v126, -v9, v78, v126
    v_fma_f32 v127, -v9, v79, v127
    v_mul_f32 v112, v13, v112
    v_mul_f32 v113, v13, v113
    v_mul_f32 v114, v13, v114
    v_mul_f32 v115, v13, v115
    v_mul_f32 v116, v13, v116
    v_mul_f32 v117, v13, v117
    v_mul_f32 v118, v13, v118
    v_mul_f32 v119, v13, v119
    v_mul_f32 v120, v13, v120
    v_mul_f32 v121, v13, v121
    v_mul_f32 v122, v13, v122
    v_mul_f32 v123, v13, v123
    v_mul_f32 v124, v13, v124
    v_mul_f32 v125, v13, v125
    v_mul_f32 v126, v13, v126
    v_mul_f32 v127, v13, v127
    v_pk_mul_f32 v[80:81], v[112:113], v[112:113]
    v_pk_mul_f32 v[82:83], v[114:115], v[114:115]
    v_pk_mul_f32 v[84:85], v[116:117], v[116:117]
    v_pk_mul_f32 v[86:87], v[118:119], v[118:119]
    v_pk_mul_f32 v[88:89], v[120:121], v[120:121]
    v_pk_mul_f32 v[90:91], v[122:123], v[122:123]
    v_pk_mul_f32 v[92:93], v[124:125], v[124:125]
    v_pk_mul_f32 v[94:95], v[126:127], v[126:127]
    v_pk_fma_f32 v[80:81], v[80:81], v[16:17], v[18:19]
    v_pk_fma_f32 v[82:83], v[82:83], v[16:17], v[18:19]
    v_pk_fma_f32 v[84:85], v[84:85], v[16:17], v[18:19]
    v_pk_fma_f32 v[86:87], v[86:87], v[16:17], v[18:19]
    v_pk_fma_f32 v[88:89], v[88:89], v[16:17], v[18:19]
    v_pk_fma_f32 v[90:91], v[90:91], v[16:17], v[18:19]
    v_pk_fma_f32 v[92:93], v[92:93], v[16:17], v[18:19]
    v_pk_fma_f32 v[94:95], v[94:95], v[16:17], v[18:19]
    v_pk_mul_f32 v[80:81], v[80:81], v[112:113]
    v_pk_mul_f32 v[82:83], v[82:83], v[114:115]
    v_pk_mul_f32 v[84:85], v[84:85], v[116:117]
    v_pk_mul_f32 v[86:87], v[86:87], v[118:119]
    v_pk_mul_f32 v[88:89], v[88:89], v[120:121]
    v_pk_mul_f32 v[90:91], v[90:91], v[122:123]
    v_pk_mul_f32 v[92:93], v[92:93], v[124:125]
    v_pk_mul_f32 v[94:95], v[94:95], v[126:127]
    v_exp_f32 v80, v80
    v_exp_f32 v81, v81
    v_exp_f32 v82, v82
    v_exp_f32 v83, v83
    v_exp_f32 v84, v84
    v_exp_f32 v85, v85
    v_exp_f32 v86, v86
    v_exp_f32 v87, v87
    v_exp_f32 v88, v88
    v_exp_f32 v89, v89
    v_exp_f32 v90, v90
    v_exp_f32 v91, v91
    v_exp_f32 v92, v92
    v_exp_f32 v93, v93
    v_exp_f32 v94, v94
    v_exp_f32 v95, v95
    v_pk_add_f32 v[80:81], v[80:81], 1.0 op_sel_hi:[1,0]
    v_pk_add_f32 v[82:83], v[82:83], 1.0 op_sel_hi:[1,0]
    v_pk_add_f32 v[84:85], v[84:85], 1.0 op_sel_hi:[1,0]
    v_pk_add_f32 v[86:87], v[86:87], 1.0 op_sel_hi:[1,0]
    v_pk_add_f32 v[88:89], v[88:89], 1.0 op_sel_hi:[1,0]
    v_pk_add_f32 v[90:91], v[90:91], 1.0 op_sel_hi:[1,0]
    v_pk_add_f32 v[92:93], v[92:93], 1.0 op_sel_hi:[1,0]
    v_pk_add_f32 v[94:95], v[94:95], 1.0 op_sel_hi:[1,0]
    v_rcp_f32 v80, v80
    v_rcp_f32 v81, v81
    v_rcp_f32 v82, v82
    v_rcp_f32 v83, v83
    v_rcp_f32 v84, v84
    v_rcp_f32 v85, v85
    v_rcp_f32 v86, v86
    v_rcp_f32 v87, v87
    v_rcp_f32 v88, v88
    v_rcp_f32 v89, v89
    v_rcp_f32 v90, v90
    v_rcp_f32 v91, v91
    v_rcp_f32 v92, v92
    v_rcp_f32 v93, v93
    v_rcp_f32 v94, v94
    v_rcp_f32 v95, v95
    v_pk_mul_f32 v[112:113], v[112:113], v[80:81]
    v_pk_mul_f32 v[114:115], v[114:115], v[82:83]
    v_pk_mul_f32 v[116:117], v[116:117], v[84:85]
    v_pk_mul_f32 v[118:119], v[118:119], v[86:87]
    v_pk_mul_f32 v[120:121], v[120:121], v[88:89]
    v_pk_mul_f32 v[122:123], v[122:123], v[90:91]
    v_pk_mul_f32 v[124:125], v[124:125], v[92:93]
    v_pk_mul_f32 v[126:127], v[126:127], v[94:95]
    v_mul_f32 v112, v21, v112
    v_mul_f32 v113, v21, v113
    v_mul_f32 v114, v21, v114
    v_mul_f32 v115, v21, v115
    v_mul_f32 v116, v21, v116
    v_mul_f32 v117, v21, v117
    v_mul_f32 v118, v21, v118
    v_mul_f32 v119, v21, v119
    v_mul_f32 v120, v21, v120
    v_mul_f32 v121, v21, v121
    v_mul_f32 v122, v21, v122
    v_mul_f32 v123, v21, v123
    v_mul_f32 v124, v21, v124
    v_mul_f32 v125, v21, v125
    v_mul_f32 v126, v21, v126
    v_mul_f32 v127, v21, v127
    v_cvt_pk_bf16_f32 v24, v112, v113
    v_cvt_pk_bf16_f32 v25, v114, v115
    v_cvt_pk_bf16_f32 v26, v116, v117
    v_cvt_pk_bf16_f32 v27, v118, v119
    v_cvt_pk_bf16_f32 v28, v120, v121
    v_cvt_pk_bf16_f32 v29, v122, v123
    v_cvt_pk_bf16_f32 v30, v124, v125
    v_cvt_pk_bf16_f32 v31, v126, v127
    s_add_u32 s50, s49, 114688
    buffer_store_dwordx4 v[24:27], v2, s[20:23], s50 offen sc1
    buffer_store_dwordx4 v[28:31], v2, s[20:23], s50 offen offset:1024 sc1
    s_nop 1
    s_add_u32 s29, s24, 16
    s_waitcnt vmcnt(0)
    s_barrier
    s_cmp_lg_u32 s26, 0
    s_cbranch_scc1 KM2_S
    s_lshl_b32 s35, s29, 8
    s_add_u32 s35, s35, 32505856
    v_mov_b32 v3, 0
    v_mov_b32 v4, 1
    s_mov_b64 s[36:37], exec
    s_mov_b64 exec, 1
    buffer_atomic_add v4, v3, s[20:23], s35 offen sc1
    s_mov_b64 exec, s[36:37]
KM2_S:
    s_and_b32 s24, s2, 31
    s_lshr_b32 s25, s2, 5
    s_mov_b32 s16, s64
    s_and_b32 s17, s65, 0xffff
    s_mov_b32 s18, 1835008
    s_mov_b32 s19, 0x00020000
    s_mul_i32 s35, s24, 229376
    s_mul_i32 s36, s26, 14336
    s_add_u32 s35, s35, s36
    s_add_u32 s35, s35, 12582912
    v_add_u32 v4, s35, v2
    v_add_u32 v5, 114688, v4
    s_mul_i32 s35, s25, 229376
    s_add_u32 s35, s35, s36
    s_add_u32 s35, s35, 26214400
    v_add_u32 v6, s35, v2
    v_add_u32 v7, 114688, v6
    s_lshl_b32 s35, s24, 16
    s_lshl_b32 s36, s26, 12
    s_add_u32 s35, s35, s36
    s_add_u32 s35, s35, 20971520
    v_add_u32 v8, s35, v2
    v_add_u32 v9, 32768, v8
    s_lshl_b32 s35, s25, 16
    s_add_u32 s35, s35, s36
    s_add_u32 s35, s35, 28311552
    v_add_u32 v10, s35, v2
    v_add_u32 v11, 32768, v10
    s_lshr_b32 s29, s24, 1
    s_add_u32 s29, s29, 16
    s_cmp_lg_u32 s26, 0
    s_cbranch_scc1 KM3a_D
    s_setprio 0
    s_lshl_b32 s36, s29, 8
    s_add_u32 s36, s36, 32505856
    v_mov_b32 v12, 0
KM3a_P:
    buffer_load_dword v13, v12, s[20:23], s36 offen sc1
    s_waitcnt vmcnt(0)
    v_readfirstlane_b32 s35, v13
    s_cmp_ge_u32 s35, 14
    s_cbranch_scc1 KM3a_D
    s_sleep 2
    s_branch KM3a_P
KM3a_D:
    s_barrier
    s_setprio 3
    s_mul_i32 s39, s26, 10240
    v_add_u32 v14, s39, v2
    s_lshr_b32 s29, s24, 1
    s_add_u32 s29, s29, 32
    s_lshl_b32 s38, s29, 8
    s_add_u32 s38, s38, 32505856
    v_mov_b32 v12, 0
    s_mov_b32 s33, 0
    s_add_u32 m0, s39, 0
    s_setprio 0
    buffer_load_dwordx4 v[80:83], v4, s[20:23], s33 offen
    buffer_load_dwordx4 v[84:87], v5, s[20:23], s33 offen
    buffer_load_dwordx4 v6, s[20:23], s33 offen lds
    s_add_u32 m0, s39, 1024
    s_nop 0
    buffer_load_dwordx4 v7, s[20:23], s33 offen lds
    s_setprio 3
    s_mov_b32 s33, 1024
    s_add_u32 m0, s39, 2048
    s_setprio 0
    buffer_load_dwordx4 v[88:91], v4, s[20:23], s33 offen
    buffer_load_dwordx4 v[92:95], v5, s[20:23], s33 offen
    buffer_load_dwordx4 v6, s[20:23], s33 offen lds
    s_add_u32 m0, s39, 3072
    s_nop 0
    buffer_load_dwordx4 v7, s[20:23], s33 offen lds
    s_setprio 3
    s_mov_b32 s33, 2048
    s_add_u32 m0, s39, 4096
    s_setprio 0
    buffer_load_dwordx4 v[96:99], v4, s[20:23], s33 offen
    buffer_load_dwordx4 v[100:103], v5, s[20:23], s33 offen
    buffer_load_dwordx4 v6, s[20:23], s33 offen lds
    s_add_u32 m0, s39, 5120
    s_nop 0
    buffer_load_dwordx4 v7, s[20:23], s33 offen lds
    s_setprio 3
    s_mov_b32 s33, 3072
    s_add_u32 m0, s39, 6144
    s_setprio 0
    buffer_load_dwordx4 v[104:107], v4, s[20:23], s33 offen
    buffer_load_dwordx4 v[108:111], v5, s[20:23], s33 offen
    buffer_load_dwordx4 v6, s[20:23], s33 offen lds
    s_add_u32 m0, s39, 7168
    s_nop 0
    buffer_load_dwordx4 v7, s[20:23], s33 offen lds
    s_setprio 3
    s_mov_b32 s33, 4096
    s_add_u32 m0, s39, 8192
    s_setprio 0
    buffer_load_dwordx4 v[112:115], v4, s[20:23], s33 offen
    buffer_load_dwordx4 v[116:119], v5, s[20:23], s33 offen
    buffer_load_dwordx4 v6, s[20:23], s33 offen lds
    s_add_u32 m0, s39, 9216
    s_nop 0
    buffer_load_dwordx4 v7, s[20:23], s33 offen lds
    s_setprio 3
    s_waitcnt vmcnt(16)
    ds_read_b128 v[120:123], v14 offset:0
    ds_read_b128 v[124:127], v14 offset:1024
    s_waitcnt lgkmcnt(1)
    v_mfma_f32_32x32x16_bf16 v[16:31], v[120:123], v[80:83], 0
    v_mfma_f32_32x32x16_bf16 v[32:47], v[120:123], v[84:87], 0
    s_waitcnt lgkmcnt(0)
    v_mfma_f32_32x32x16_bf16 v[48:63], v[124:127], v[80:83], 0
    v_mfma_f32_32x32x16_bf16 v[64:79], v[124:127], v[84:87], 0
    s_mov_b32 s33, 5120
    s_add_u32 m0, s39, 0
    s_setprio 0
    buffer_load_dwordx4 v[80:83], v4, s[20:23], s33 offen
    buffer_load_dwordx4 v[84:87], v5, s[20:23], s33 offen
    buffer_load_dwordx4 v6, s[20:23], s33 offen lds
    s_add_u32 m0, s39, 1024
    s_nop 0
    buffer_load_dwordx4 v7, s[20:23], s33 offen lds
    s_setprio 3
    s_waitcnt vmcnt(16)
    ds_read_b128 v[120:123], v14 offset:2048
    ds_read_b128 v[124:127], v14 offset:3072
    s_waitcnt lgkmcnt(1)
    v_mfma_f32_32x32x16_bf16 v[16:31], v[120:123], v[88:91], v[16:31]
    v_mfma_f32_32x32x16_bf16 v[32:47], v[120:123], v[92:95], v[32:47]
    s_waitcnt lgkmcnt(0)
    v_mfma_f32_32x32x16_bf16 v[48:63], v[124:127], v[88:91], v[48:63]
    v_mfma_f32_32x32x16_bf16 v[64:79], v[124:127], v[92:95], v[64:79]
    s_mov_b32 s33, 6144
    s_add_u32 m0, s39, 2048
    s_setprio 0
    buffer_load_dwordx4 v[88:91], v4, s[20:23], s33 offen
    buffer_load_dwordx4 v[92:95], v5, s[20:23], s33 offen
    buffer_load_dwordx4 v6, s[20:23], s33 offen lds
    s_add_u32 m0, s39, 3072
    s_nop 0
    buffer_load_dwordx4 v7, s[20:23], s33 offen lds
    s_setprio 3
    s_waitcnt vmcnt(16)
    ds_read_b128 v[120:123], v14 offset:4096
    ds_read_b128 v[124:127], v14 offset:5120
    s_waitcnt lgkmcnt(1)
    v_mfma_f32_32x32x16_bf16 v[16:31], v[120:123], v[96:99], v[16:31]
    v_mfma_f32_32x32x16_bf16 v[32:47], v[120:123], v[100:103], v[32:47]
    s_waitcnt lgkmcnt(0)
    v_mfma_f32_32x32x16_bf16 v[48:63], v[124:127], v[96:99], v[48:63]
    v_mfma_f32_32x32x16_bf16 v[64:79], v[124:127], v[100:103], v[64:79]
    s_mov_b32 s33, 7168
    s_add_u32 m0, s39, 4096
    s_setprio 0
    buffer_load_dwordx4 v[96:99], v4, s[20:23], s33 offen
    buffer_load_dwordx4 v[100:103], v5, s[20:23], s33 offen
    buffer_load_dwordx4 v6, s[20:23], s33 offen lds
    s_add_u32 m0, s39, 5120
    s_nop 0
    buffer_load_dwordx4 v7, s[20:23], s33 offen lds
    s_setprio 3
    s_waitcnt vmcnt(16)
    ds_read_b128 v[120:123], v14 offset:6144
    ds_read_b128 v[124:127], v14 offset:7168
    s_waitcnt lgkmcnt(1)
    v_mfma_f32_32x32x16_bf16 v[16:31], v[120:123], v[104:107], v[16:31]
    v_mfma_f32_32x32x16_bf16 v[32:47], v[120:123], v[108:111], v[32:47]
    s_waitcnt lgkmcnt(0)
    v_mfma_f32_32x32x16_bf16 v[48:63], v[124:127], v[104:107], v[48:63]
    v_mfma_f32_32x32x16_bf16 v[64:79], v[124:127], v[108:111], v[64:79]
    s_mov_b32 s33, 8192
    s_add_u32 m0, s39, 6144
    s_setprio 0
    buffer_load_dwordx4 v[104:107], v4, s[20:23], s33 offen
    buffer_load_dwordx4 v[108:111], v5, s[20:23], s33 offen
    buffer_load_dwordx4 v6, s[20:23], s33 offen lds
    s_add_u32 m0, s39, 7168
    s_nop 0
    buffer_load_dwordx4 v7, s[20:23], s33 offen lds
    s_setprio 3
    s_waitcnt vmcnt(16)
    ds_read_b128 v[120:123], v14 offset:8192
    ds_read_b128 v[124:127], v14 offset:9216
    s_waitcnt lgkmcnt(1)
    v_mfma_f32_32x32x16_bf16 v[16:31], v[120:123], v[112:115], v[16:31]
    v_mfma_f32_32x32x16_bf16 v[32:47], v[120:123], v[116:119], v[32:47]
    s_waitcnt lgkmcnt(0)
    v_mfma_f32_32x32x16_bf16 v[48:63], v[124:127], v[112:115], v[48:63]
    v_mfma_f32_32x32x16_bf16 v[64:79], v[124:127], v[116:119], v[64:79]
    s_mov_b32 s33, 9216
    s_add_u32 m0, s39, 8192
    s_setprio 0
    buffer_load_dwordx4 v[112:115], v4, s[20:23], s33 offen
    buffer_load_dwordx4 v[116:119], v5, s[20:23], s33 offen
    buffer_load_dwordx4 v6, s[20:23], s33 offen lds
    s_add_u32 m0, s39, 9216
    s_nop 0
    buffer_load_dwordx4 v7, s[20:23], s33 offen lds
    s_setprio 3
    s_waitcnt vmcnt(16)
    ds_read_b128 v[120:123], v14 offset:0
    ds_read_b128 v[124:127], v14 offset:1024
    s_waitcnt lgkmcnt(1)
    v_mfma_f32_32x32x16_bf16 v[16:31], v[120:123], v[80:83], v[16:31]
    v_mfma_f32_32x32x16_bf16 v[32:47], v[120:123], v[84:87], v[32:47]
    s_waitcnt lgkmcnt(0)
    v_mfma_f32_32x32x16_bf16 v[48:63], v[124:127], v[80:83], v[48:63]
    v_mfma_f32_32x32x16_bf16 v[64:79], v[124:127], v[84:87], v[64:79]
    s_mov_b32 s33, 10240
    s_add_u32 m0, s39, 0
    s_setprio 0
    buffer_load_dwordx4 v[80:83], v4, s[20:23], s33 offen
    buffer_load_dwordx4 v[84:87], v5, s[20:23], s33 offen
    buffer_load_dwordx4 v6, s[20:23], s33 offen lds
    s_add_u32 m0, s39, 1024
    s_nop 0
    buffer_load_dwordx4 v7, s[20:23], s33 offen lds
    s_setprio 3
    buffer_load_dword v13, v12, s[20:23], s38 offen sc1
    s_waitcnt vmcnt(17)
    ds_read_b128 v[120:123], v14 offset:2048
    ds_read_b128 v[124:127], v14 offset:3072
    s_waitcnt lgkmcnt(1)
    v_mfma_f32_32x32x16_bf16 v[16:31], v[120:123], v[88:91], v[16:31]
    v_mfma_f32_32x32x16_bf16 v[32:47], v[120:123], v[92:95], v[32:47]
    s_waitcnt lgkmcnt(0)
    v_mfma_f32_32x32x16_bf16 v[48:63], v[124:127], v[88:91], v[48:63]
    v_mfma_f32_32x32x16_bf16 v[64:79], v[124:127], v[92:95], v[64:79]
    s_mov_b32 s33, 11264
    s_add_u32 m0, s39, 2048
    s_setprio 0
    buffer_load_dwordx4 v[88:91], v4, s[20:23], s33 offen
    buffer_load_dwordx4 v[92:95], v5, s[20:23], s33 offen
    buffer_load_dwordx4 v6, s[20:23], s33 offen lds
    s_add_u32 m0, s39, 3072
    s_nop 0
    buffer_load_dwordx4 v7, s[20:23], s33 offen lds
    s_setprio 3
    s_waitcnt vmcnt(17)
    ds_read_b128 v[120:123], v14 offset:4096
    ds_read_b128 v[124:127], v14 offset:5120
    s_waitcnt lgkmcnt(1)
    v_mfma_f32_32x32x16_bf16 v[16:31], v[120:123], v[96:99], v[16:31]
    v_mfma_f32_32x32x16_bf16 v[32:47], v[120:123], v[100:103], v[32:47]
    s_waitcnt lgkmcnt(0)
    v_mfma_f32_32x32x16_bf16 v[48:63], v[124:127], v[96:99], v[48:63]
    v_mfma_f32_32x32x16_bf16 v[64:79], v[124:127], v[100:103], v[64:79]
    s_mov_b32 s33, 12288
    s_add_u32 m0, s39, 4096
    s_setprio 0
    buffer_load_dwordx4 v[96:99], v4, s[20:23], s33 offen
    buffer_load_dwordx4 v[100:103], v5, s[20:23], s33 offen
    buffer_load_dwordx4 v6, s[20:23], s33 offen lds
    s_add_u32 m0, s39, 5120
    s_nop 0
    buffer_load_dwordx4 v7, s[20:23], s33 offen lds
    s_setprio 3
    s_waitcnt vmcnt(17)
    ds_read_b128 v[120:123], v14 offset:6144
    ds_read_b128 v[124:127], v14 offset:7168
    s_waitcnt lgkmcnt(1)
    v_mfma_f32_32x32x16_bf16 v[16:31], v[120:123], v[104:107], v[16:31]
    v_mfma_f32_32x32x16_bf16 v[32:47], v[120:123], v[108:111], v[32:47]
    s_waitcnt lgkmcnt(0)
    v_mfma_f32_32x32x16_bf16 v[48:63], v[124:127], v[104:107], v[48:63]
    v_mfma_f32_32x32x16_bf16 v[64:79], v[124:127], v[108:111], v[64:79]
    s_mov_b32 s33, 13312
    s_add_u32 m0, s39, 6144
    s_setprio 0
    buffer_load_dwordx4 v[104:107], v4, s[20:23], s33 offen
    buffer_load_dwordx4 v[108:111], v5, s[20:23], s33 offen
    buffer_load_dwordx4 v6, s[20:23], s33 offen lds
    s_add_u32 m0, s39, 7168
    s_nop 0
    buffer_load_dwordx4 v7, s[20:23], s33 offen lds
    s_setprio 3
    s_waitcnt vmcnt(17)
    ds_read_b128 v[120:123], v14 offset:8192
    ds_read_b128 v[124:127], v14 offset:9216
    s_waitcnt lgkmcnt(1)
    v_mfma_f32_32x32x16_bf16 v[16:31], v[120:123], v[112:115], v[16:31]
    v_mfma_f32_32x32x16_bf16 v[32:47], v[120:123], v[116:119], v[32:47]
    s_waitcnt lgkmcnt(0)
    v_mfma_f32_32x32x16_bf16 v[48:63], v[124:127], v[112:115], v[48:63]
    v_mfma_f32_32x32x16_bf16 v[64:79], v[124:127], v[116:119], v[64:79]
    s_waitcnt vmcnt(13)
    ds_read_b128 v[120:123], v14 offset:0
    ds_read_b128 v[124:127], v14 offset:1024
    s_waitcnt lgkmcnt(1)
    v_mfma_f32_32x32x16_bf16 v[16:31], v[120:123], v[80:83], v[16:31]
    v_mfma_f32_32x32x16_bf16 v[32:47], v[120:123], v[84:87], v[32:47]
    s_waitcnt lgkmcnt(0)
    v_mfma_f32_32x32x16_bf16 v[48:63], v[124:127], v[80:83], v[48:63]
    v_mfma_f32_32x32x16_bf16 v[64:79], v[124:127], v[84:87], v[64:79]
    s_waitcnt vmcnt(8)
    ds_read_b128 v[120:123], v14 offset:2048
    ds_read_b128 v[124:127], v14 offset:3072
    s_waitcnt lgkmcnt(1)
    v_mfma_f32_32x32x16_bf16 v[16:31], v[120:123], v[88:91], v[16:31]
    v_mfma_f32_32x32x16_bf16 v[32:47], v[120:123], v[92:95], v[32:47]
    s_waitcnt lgkmcnt(0)
    v_mfma_f32_32x32x16_bf16 v[48:63], v[124:127], v[88:91], v[48:63]
    v_mfma_f32_32x32x16_bf16 v[64:79], v[124:127], v[92:95], v[64:79]
    s_waitcnt vmcnt(4)
    ds_read_b128 v[120:123], v14 offset:4096
    ds_read_b128 v[124:127], v14 offset:5120
    s_waitcnt lgkmcnt(1)
    v_mfma_f32_32x32x16_bf16 v[16:31], v[120:123], v[96:99], v[16:31]
    v_mfma_f32_32x32x16_bf16 v[32:47], v[120:123], v[100:103], v[32:47]
    s_waitcnt lgkmcnt(0)
    v_mfma_f32_32x32x16_bf16 v[48:63], v[124:127], v[96:99], v[48:63]
    v_mfma_f32_32x32x16_bf16 v[64:79], v[124:127], v[100:103], v[64:79]
    s_waitcnt vmcnt(0)
    ds_read_b128 v[120:123], v14 offset:6144
    ds_read_b128 v[124:127], v14 offset:7168
    s_waitcnt lgkmcnt(1)
    v_mfma_f32_32x32x16_bf16 v[16:31], v[120:123], v[104:107], v[16:31]
    v_mfma_f32_32x32x16_bf16 v[32:47], v[120:123], v[108:111], v[32:47]
    s_waitcnt lgkmcnt(0)
    v_mfma_f32_32x32x16_bf16 v[48:63], v[124:127], v[104:107], v[48:63]
    v_mfma_f32_32x32x16_bf16 v[64:79], v[124:127], v[108:111], v[64:79]
KM3b_P:
    s_waitcnt vmcnt(0)
    v_readfirstlane_b32 s35, v13
    s_cmp_ge_u32 s35, 16
    s_cbranch_scc1 KM3b_D
    s_sleep 8
    buffer_load_dword v13, v12, s[20:23], s38 offen sc1
    s_branch KM3b_P
KM3b_D:
    s_mov_b32 s33, 0
    s_add_u32 m0, s39, 8192
    s_setprio 0
    buffer_load_dwordx4 v[112:115], v8, s[20:23], s33 offen
    buffer_load_dwordx4 v[116:119], v9, s[20:23], s33 offen
    buffer_load_dwordx4 v10, s[20:23], s33 offen lds
    s_add_u32 m0, s39, 9216
    s_nop 0
    buffer_load_dwordx4 v11, s[20:23], s33 offen lds
    s_setprio 3
    s_mov_b32 s33, 1024
    s_add_u32 m0, s39, 0
    s_setprio 0
    buffer_load_dwordx4 v[80:83], v8, s[20:23], s33 offen
    buffer_load_dwordx4 v[84:87], v9, s[20:23], s33 offen
    buffer_load_dwordx4 v10, s[20:23], s33 offen lds
    s_add_u32 m0, s39, 1024
    s_nop 0
    buffer_load_dwordx4 v11, s[20:23], s33 offen lds
    s_setprio 3
    s_mov_b32 s33, 2048
    s_add_u32 m0, s39, 2048
    s_setprio 0
    buffer_load_dwordx4 v[88:91], v8, s[20:23], s33 offen
    buffer_load_dwordx4 v[92:95], v9, s[20:23], s33 offen
    buffer_load_dwordx4 v10, s[20:23], s33 offen lds
    s_add_u32 m0, s39, 3072
    s_nop 0
    buffer_load_dwordx4 v11, s[20:23], s33 offen lds
    s_setprio 3
    s_mov_b32 s33, 3072
    s_add_u32 m0, s39, 4096
    s_setprio 0
    buffer_load_dwordx4 v[96:99], v8, s[20:23], s33 offen
    buffer_load_dwordx4 v[100:103], v9, s[20:23], s33 offen
    buffer_load_dwordx4 v10, s[20:23], s33 offen lds
    s_add_u32 m0, s39, 5120
    s_nop 0
    buffer_load_dwordx4 v11, s[20:23], s33 offen lds
    s_setprio 3
    s_waitcnt vmcnt(12)
    ds_read_b128 v[120:123], v14 offset:8192
    ds_read_b128 v[124:127], v14 offset:9216
    s_waitcnt lgkmcnt(1)
    v_mfma_f32_32x32x16_bf16 v[16:31], v[120:123], v[112:115], v[16:31]
    v_mfma_f32_32x32x16_bf16 v[32:47], v[120:123], v[116:119], v[32:47]
    s_waitcnt lgkmcnt(0)
    v_mfma_f32_32x32x16_bf16 v[48:63], v[124:127], v[112:115], v[48:63]
    v_mfma_f32_32x32x16_bf16 v[64:79], v[124:127], v[116:119], v[64:79]
    s_waitcnt vmcnt(8)
    ds_read_b128 v[120:123], v14 offset:0
    ds_read_b128 v[124:127], v14 offset:1024
    s_waitcnt lgkmcnt(1)
    v_mfma_f32_32x32x16_bf16 v[16:31], v[120:123], v[80:83], v[16:31]
    v_mfma_f32_32x32x16_bf16 v[32:47], v[120:123], v[84:87], v[32:47]
    s_waitcnt lgkmcnt(0)
    v_mfma_f32_32x32x16_bf16 v[48:63], v[124:127], v[80:83], v[48:63]
    v_mfma_f32_32x32x16_bf16 v[64:79], v[124:127], v[84:87], v[64:79]
    s_waitcnt vmcnt(4)
    ds_read_b128 v[120:123], v14 offset:2048
    ds_read_b128 v[124:127], v14 offset:3072
    s_waitcnt lgkmcnt(1)
    v_mfma_f32_32x32x16_bf16 v[16:31], v[120:123], v[88:91], v[16:31]
    v_mfma_f32_32x32x16_bf16 v[32:47], v[120:123], v[92:95], v[32:47]
    s_waitcnt lgkmcnt(0)
    v_mfma_f32_32x32x16_bf16 v[48:63], v[124:127], v[88:91], v[48:63]
    v_mfma_f32_32x32x16_bf16 v[64:79], v[124:127], v[92:95], v[64:79]
    s_waitcnt vmcnt(0)
    ds_read_b128 v[120:123], v14 offset:4096
    ds_read_b128 v[124:127], v14 offset:5120
    s_waitcnt lgkmcnt(1)
    v_mfma_f32_32x32x16_bf16 v[16:31], v[120:123], v[96:99], v[16:31]
    v_mfma_f32_32x32x16_bf16 v[32:47], v[120:123], v[100:103], v[32:47]
    s_waitcnt lgkmcnt(0)
    v_mfma_f32_32x32x16_bf16 v[48:63], v[124:127], v[96:99], v[48:63]
    v_mfma_f32_32x32x16_bf16 v[64:79], v[124:127], v[100:103], v[64:79]
    s_barrier
    s_and_b32 s46, s26, 3
    s_lshl_b32 s35, s46, 14
    v_add_u32 v3, s35, v2
    s_lshl_b32 s35, s24, 1
    s_and_b32 s36, s46, 1
    s_add_u32 s27, s35, s36
    s_lshl_b32 s35, s25, 1
    s_lshr_b32 s36, s46, 1
    s_add_u32 s28, s35, s36
    s_nop 7
    s_nop 3
    s_cmp_lt_u32 s26, 4
    s_cbranch_scc1 KM3_R1
    ds_write_b128 v3, v[16:19] offset:0
    ds_write_b128 v3, v[20:23] offset:1024
    ds_write_b128 v3, v[24:27] offset:2048
    ds_write_b128 v3, v[28:31] offset:3072
    ds_write_b128 v3, v[32:35] offset:4096
    ds_write_b128 v3, v[36:39] offset:5120
    ds_write_b128 v3, v[40:43] offset:6144
    ds_write_b128 v3, v[44:47] offset:7168
    ds_write_b128 v3, v[48:51] offset:8192
    ds_write_b128 v3, v[52:55] offset:9216
    ds_write_b128 v3, v[56:59] offset:10240
    ds_write_b128 v3, v[60:63] offset:11264
    ds_write_b128 v3, v[64:67] offset:12288
    ds_write_b128 v3, v[68:71] offset:13312
    ds_write_b128 v3, v[72:75] offset:14336
    ds_write_b128 v3, v[76:79] offset:15360
    s_waitcnt lgkmcnt(0)
    s_barrier
    s_barrier
    s_barrier
    s_branch KM_END2
KM3_R1:
    v_and_b32 v4, 31, v1
    v_lshlrev_b32 v4, 2, v4
    s_lshl_b32 s35, s27, 7
    s_add_u32 s35, s35, 29360128
    buffer_load_dword v12, v4, s[20:23], s35 offen
    s_mul_i32 s35, s27, 28672
    s_lshl_b32 s36, s28, 11
    s_add_u32 s35, s35, s36
    s_add_u32 s35, s35, 10485760
    buffer_load_dwordx4 v[4:7], v2, s[20:23], s35 offen
    buffer_load_dwordx4 v[8:11], v2, s[20:23], s35 offen offset:1024
    s_barrier
    ds_read_b128 v[80:83], v3 offset:0
    ds_read_b128 v[84:87], v3 offset:1024
    ds_read_b128 v[88:91], v3 offset:2048
    ds_read_b128 v[92:95], v3 offset:3072
    ds_read_b128 v[96:99], v3 offset:4096
    ds_read_b128 v[100:103], v3 offset:5120
    ds_read_b128 v[104:107], v3 offset:6144
    ds_read_b128 v[108:111], v3 offset:7168
    s_waitcnt lgkmcnt(0)
    v_add_f32 v16, v16, v80
    v_add_f32 v17, v17, v81
    v_add_f32 v18, v18, v82
    v_add_f32 v19, v19, v83
    v_add_f32 v20, v20, v84
    v_add_f32 v21, v21, v85
    v_add_f32 v22, v22, v86
    v_add_f32 v23, v23, v87
    v_add_f32 v24, v24, v88
    v_add_f32 v25, v25, v89
    v_add_f32 v26, v26, v90
    v_add_f32 v27, v27, v91
    v_add_f32 v28, v28, v92
    v_add_f32 v29, v29, v93
    v_add_f32 v30, v30, v94
    v_add_f32 v31, v31, v95
    v_add_f32 v32, v32, v96
    v_add_f32 v33, v33, v97
    v_add_f32 v34, v34, v98
    v_add_f32 v35, v35, v99
    v_add_f32 v36, v36, v100
    v_add_f32 v37, v37, v101
    v_add_f32 v38, v38, v102
    v_add_f32 v39, v39, v103
    v_add_f32 v40, v40, v104
    v_add_f32 v41, v41, v105
    v_add_f32 v42, v42, v106
    v_add_f32 v43, v43, v107
    v_add_f32 v44, v44, v108
    v_add_f32 v45, v45, v109
    v_add_f32 v46, v46, v110
    v_add_f32 v47, v47, v111
    ds_read_b128 v[80:83], v3 offset:8192
    ds_read_b128 v[84:87], v3 offset:9216
    ds_read_b128 v[88:91], v3 offset:10240
    ds_read_b128 v[92:95], v3 offset:11264
    ds_read_b128 v[96:99], v3 offset:12288
    ds_read_b128 v[100:103], v3 offset:13312
    ds_read_b128 v[104:107], v3 offset:14336
    ds_read_b128 v[108:111], v3 offset:15360
    s_waitcnt lgkmcnt(0)
    v_add_f32 v48, v48, v80
    v_add_f32 v49, v49, v81
    v_add_f32 v50, v50, v82
    v_add_f32 v51, v51, v83
    v_add_f32 v52, v52, v84
    v_add_f32 v53, v53, v85
    v_add_f32 v54, v54, v86
    v_add_f32 v55, v55, v87
    v_add_f32 v56, v56, v88
    v_add_f32 v57, v57, v89
    v_add_f32 v58, v58, v90
    v_add_f32 v59, v59, v91
    v_add_f32 v60, v60, v92
    v_add_f32 v61, v61, v93
    v_add_f32 v62, v62, v94
    v_add_f32 v63, v63, v95
    v_add_f32 v64, v64, v96
    v_add_f32 v65, v65, v97
    v_add_f32 v66, v66, v98
    v_add_f32 v67, v67, v99
    v_add_f32 v68, v68, v100
    v_add_f32 v69, v69, v101
    v_add_f32 v70, v70, v102
    v_add_f32 v71, v71, v103
    v_add_f32 v72, v72, v104
    v_add_f32 v73, v73, v105
    v_add_f32 v74, v74, v106
    v_add_f32 v75, v75, v107
    v_add_f32 v76, v76, v108
    v_add_f32 v77, v77, v109
    v_add_f32 v78, v78, v110
    v_add_f32 v79, v79, v111
    s_barrier
    s_mul_i32 s35, s26, 12288
    v_add_u32 v13, s35, v2
    s_cmp_eq_u32 s26, 0
    s_cbranch_scc1 KM3_SK0
    s_cmp_gt_u32 s26, 0
    s_cselect_b32 s35, 1, 0
    s_sub_u32 s35, s26, s35
    s_lshl_b32 s35, s35, 12
    v_add_u32 v3, s35, v2
    ds_write_b128 v3, v[16:19] offset:0
    ds_write_b128 v3, v[20:23] offset:1024
    ds_write_b128 v3, v[24:27] offset:2048
    ds_write_b128 v3, v[28:31] offset:3072
KM3_SK0:
    s_cmp_eq_u32 s26, 1
    s_cbranch_scc1 KM3_SK1
    s_cmp_gt_u32 s26, 1
    s_cselect_b32 s35, 1, 0
    s_sub_u32 s35, s26, s35
    s_lshl_b32 s35, s35, 12
    v_add_u32 v3, s35, v2
    ds_write_b128 v3, v[32:35] offset:12288
    ds_write_b128 v3, v[36:39] offset:13312
    ds_write_b128 v3, v[40:43] offset:14336
    ds_write_b128 v3, v[44:47] offset:15360
KM3_SK1:
    s_cmp_eq_u32 s26, 2
    s_cbranch_scc1 KM3_SK2
    s_cmp_gt_u32 s26, 2
    s_cselect_b32 s35, 1, 0
    s_sub_u32 s35, s26, s35
    s_lshl_b32 s35, s35, 12
    v_add_u32 v3, s35, v2
    ds_write_b128 v3, v[48:51] offset:24576
    ds_write_b128 v3, v[52:55] offset:25600
    ds_write_b128 v3, v[56:59] offset:26624
    ds_write_b128 v3, v[60:63] offset:27648
KM3_SK2:
    s_cmp_eq_u32 s26, 3
    s_cbranch_scc1 KM3_SK3
    s_cmp_gt_u32 s26, 3
    s_cselect_b32 s35, 1, 0
    s_sub_u32 s35, s26, s35
    s_lshl_b32 s35, s35, 12
    v_add_u32 v3, s35, v2
    ds_write_b128 v3, v[64:67] offset:36864
    ds_write_b128 v3, v[68:71] offset:37888
    ds_write_b128 v3, v[72:75] offset:38912
    ds_write_b128 v3, v[76:79] offset:39936
KM3_SK3:
    s_cmp_lg_u32 s26, 1
    s_cbranch_scc1 KM3_MV1
    v_mov_b32 v16, v32
    v_mov_b32 v17, v33
    v_mov_b32 v18, v34
    v_mov_b32 v19, v35
    v_mov_b32 v20, v36
    v_mov_b32 v21, v37
    v_mov_b32 v22, v38
    v_mov_b32 v23, v39
    v_mov_b32 v24, v40
    v_mov_b32 v25, v41
    v_mov_b32 v26, v42
    v_mov_b32 v27, v43
    v_mov_b32 v28, v44
    v_mov_b32 v29, v45
    v_mov_b32 v30, v46
    v_mov_b32 v31, v47
KM3_MV1:
    s_cmp_lg_u32 s26, 2
    s_cbranch_scc1 KM3_MV2
    v_mov_b32 v16, v48
    v_mov_b32 v17, v49
    v_mov_b32 v18, v50
    v_mov_b32 v19, v51
    v_mov_b32 v20, v52
    v_mov_b32 v21, v53
    v_mov_b32 v22, v54
    v_mov_b32 v23, v55
    v_mov_b32 v24, v56
    v_mov_b32 v25, v57
    v_mov_b32 v26, v58
    v_mov_b32 v27, v59
    v_mov_b32 v28, v60
    v_mov_b32 v29, v61
    v_mov_b32 v30, v62
    v_mov_b32 v31, v63
KM3_MV2:
    s_cmp_lg_u32 s26, 3
    s_cbranch_scc1 KM3_MV3
    v_mov_b32 v16, v64
    v_mov_b32 v17, v65
    v_mov_b32 v18, v66
    v_mov_b32 v19, v67
    v_mov_b32 v20, v68
    v_mov_b32 v21, v69
    v_mov_b32 v22, v70
    v_mov_b32 v23, v71
    v_mov_b32 v24, v72
    v_mov_b32 v25, v73
    v_mov_b32 v26, v74
    v_mov_b32 v27, v75
    v_mov_b32 v28, v76
    v_mov_b32 v29, v77
    v_mov_b32 v30, v78
    v_mov_b32 v31, v79
KM3_MV3:
    s_waitcnt lgkmcnt(0)
    s_barrier
    ds_read_b128 v[80:83], v13 offset:0
    ds_read_b128 v[84:87], v13 offset:1024
    ds_read_b128 v[88:91], v13 offset:2048
    ds_read_b128 v[92:95], v13 offset:3072
    ds_read_b128 v[96:99], v13 offset:4096
    ds_read_b128 v[100:103], v13 offset:5120
    ds_read_b128 v[104:107], v13 offset:6144
    ds_read_b128 v[108:111], v13 offset:7168
    ds_read_b128 v[112:115], v13 offset:8192
    ds_read_b128 v[116:119], v13 offset:9216
    ds_read_b128 v[120:123], v13 offset:10240
    ds_read_b128 v[124:127], v13 offset:11264
    s_waitcnt lgkmcnt(8)
    v_add_f32 v16, v16, v80
    v_add_f32 v17, v17, v81
    v_add_f32 v18, v18, v82
    v_add_f32 v19, v19, v83
    v_add_f32 v20, v20, v84
    v_add_f32 v21, v21, v85
    v_add_f32 v22, v22, v86
    v_add_f32 v23, v23, v87
    v_add_f32 v24, v24, v88
    v_add_f32 v25, v25, v89
    v_add_f32 v26, v26, v90
    v_add_f32 v27, v27, v91
    v_add_f32 v28, v28, v92
    v_add_f32 v29, v29, v93
    v_add_f32 v30, v30, v94
    v_add_f32 v31, v31, v95
    s_waitcnt lgkmcnt(4)
    v_add_f32 v16, v16, v96
    v_add_f32 v17, v17, v97
    v_add_f32 v18, v18, v98
    v_add_f32 v19, v19, v99
    v_add_f32 v20, v20, v100
    v_add_f32 v21, v21, v101
    v_add_f32 v22, v22, v102
    v_add_f32 v23, v23, v103
    v_add_f32 v24, v24, v104
    v_add_f32 v25, v25, v105
    v_add_f32 v26, v26, v106
    v_add_f32 v27, v27, v107
    v_add_f32 v28, v28, v108
    v_add_f32 v29, v29, v109
    v_add_f32 v30, v30, v110
    v_add_f32 v31, v31, v111
    s_waitcnt lgkmcnt(0)
    v_add_f32 v16, v16, v112
    v_add_f32 v17, v17, v113
    v_add_f32 v18, v18, v114
    v_add_f32 v19, v19, v115
    v_add_f32 v20, v20, v116
    v_add_f32 v21, v21, v117
    v_add_f32 v22, v22, v118
    v_add_f32 v23, v23, v119
    v_add_f32 v24, v24, v120
    v_add_f32 v25, v25, v121
    v_add_f32 v26, v26, v122
    v_add_f32 v27, v27, v123
    v_add_f32 v28, v28, v124
    v_add_f32 v29, v29, v125
    v_add_f32 v30, v30, v126
    v_add_f32 v31, v31, v127
    s_waitcnt vmcnt(0)
    v_sub_f32 v14, 1.0, v12
    v_mov_b32 v32, 0xffff0000
    v_and_b32 v3, 31, v1
    s_lshl_b32 s35, s27, 5
    v_add_u32 v3, s35, v3
    v_mul_u32_u24 v3, 896, v3
    v_lshrrev_b32 v13, 5, v1
    v_lshl_add_u32 v3, v13, 3, v3
    s_lshl_b32 s35, s28, 6
    v_lshlrev_b32 v33, 16, v4
    v_and_b32 v34, v32, v4
    v_fmac_f32 v16, v14, v33
    v_fmac_f32 v17, v14, v34
    v_lshlrev_b32 v33, 16, v5
    v_and_b32 v34, v32, v5
    v_fmac_f32 v18, v14, v33
    v_fmac_f32 v19, v14, v34
    v_lshlrev_b32 v33, 16, v6
    v_and_b32 v34, v32, v6
    v_fmac_f32 v20, v14, v33
    v_fmac_f32 v21, v14, v34
    v_lshlrev_b32 v33, 16, v7
    v_and_b32 v34, v32, v7
    v_fmac_f32 v22, v14, v33
    v_fmac_f32 v23, v14, v34
    v_lshlrev_b32 v33, 16, v8
    v_and_b32 v34, v32, v8
    v_fmac_f32 v24, v14, v33
    v_fmac_f32 v25, v14, v34
    v_lshlrev_b32 v33, 16, v9
    v_and_b32 v34, v32, v9
    v_fmac_f32 v26, v14, v33
    v_fmac_f32 v27, v14, v34
    v_lshlrev_b32 v33, 16, v10
    v_and_b32 v34, v32, v10
    v_fmac_f32 v28, v14, v33
    v_fmac_f32 v29, v14, v34
    v_lshlrev_b32 v33, 16, v11
    v_and_b32 v34, v32, v11
    v_fmac_f32 v30, v14, v33
    v_fmac_f32 v31, v14, v34
    v_cvt_pk_bf16_f32 v40, v16, v17
    v_cvt_pk_bf16_f32 v41, v18, v19
    v_cvt_pk_bf16_f32 v42, v20, v21
    v_cvt_pk_bf16_f32 v43, v22, v23
    v_cvt_pk_bf16_f32 v44, v24, v25
    v_cvt_pk_bf16_f32 v45, v26, v27
    v_cvt_pk_bf16_f32 v46, v28, v29
    v_cvt_pk_bf16_f32 v47, v30, v31
    buffer_store_dwordx2 v[40:41], v3, s[16:19], s35 offen offset:0
    buffer_store_dwordx2 v[42:43], v3, s[16:19], s35 offen offset:16
    buffer_store_dwordx2 v[44:45], v3, s[16:19], s35 offen offset:32
    buffer_store_dwordx2 v[46:47], v3, s[16:19], s35 offen offset:48
    s_branch KM_END2
KM_ATTN:
    s_setprio 2
    s_sub_u32 s3, s2, 224
    s_and_b32 s24, s3, 15
    s_lshr_b32 s25, s3, 4
    s_and_b32 s46, s26, 3
    s_lshr_b32 s47, s26, 2
    s_lshl_b32 s27, s25, 2
    s_add_u32 s27, s27, s46
    s_lshl_b32 s28, s24, 17
    s_lshl_b32 s35, s27, 11
    s_add_u32 s35, s35, s28
    buffer_load_dwordx4 v[8:11], v2, s[20:23], s35 offen
    buffer_load_dwordx4 v[12:15], v2, s[20:23], s35 offen offset:1024
    s_lshl_b32 s29, s26, 11
    s_lshl_b32 s30, s47, 16
    s_and_b32 s35, s46, 1
    s_lshl_b32 s35, s35, 11
    s_add_u32 s30, s30, s35
    s_add_u32 s30, s30, s28
    s_cmp_lt_u32 s46, 2
    s_mov_b32 s35, 4194304
    s_cselect_b32 s35, 2097152, s35
    s_add_u32 s30, s30, s35
    s_lshl_b32 s35, s47, 13
    v_add_u32 v3, s35, v2
    s_mov_b32 s44, 1
    s_mov_b32 s45, 0
KMA_START:
    s_mov_b32 s33, 0
    s_mov_b32 s34, s30
    s_add_u32 s37, s28, 2097152
    buffer_load_dwordx4 v[16:19], v2, s[20:23], s37 offen
    buffer_load_dwordx4 v[20:23], v2, s[20:23], s37 offen offset:1024
    s_add_u32 m0, s33, s29
    s_add_u32 s33, s33, 16384
    buffer_load_dwordx4 v2, s[20:23], s34 offen lds
    buffer_load_dwordx4 v2, s[20:23], s34 offen offset:1024 lds
    s_add_u32 s34, s34, 4096
    s_cmp_ge_u32 s33, 81920
    s_cselect_b32 s33, 0, s33
    s_add_u32 m0, s33, s29
    s_add_u32 s33, s33, 16384
    buffer_load_dwordx4 v2, s[20:23], s34 offen lds
    buffer_load_dwordx4 v2, s[20:23], s34 offen offset:1024 lds
    s_add_u32 s34, s34, 4096
    s_cmp_ge_u32 s33, 81920
    s_cselect_b32 s33, 0, s33
    s_add_u32 m0, s33, s29
    s_add_u32 s33, s33, 16384
    buffer_load_dwordx4 v2, s[20:23], s34 offen lds
    buffer_load_dwordx4 v2, s[20:23], s34 offen offset:1024 lds
    s_add_u32 s34, s34, 4096
    s_cmp_ge_u32 s33, 81920
    s_cselect_b32 s33, 0, s33
    s_mov_b32 s38, s44
    v_mov_b32 v4, 0xff800000
    s_waitcnt vmcnt(6)
    v_cndmask_b32 v14, v14, 0, s[60:61]
    s_branch KMA_MAXE
KMA_MAXL:
    buffer_load_dwordx4 v[16:19], v2, s[20:23], s37 offen
    buffer_load_dwordx4 v[20:23], v2, s[20:23], s37 offen offset:1024
    s_waitcnt vmcnt(0)
KMA_MAXE:
    s_nop 1
    v_mfma_f32_32x32x16_bf16 v[48:63], v[16:19], v[8:11], 0
    v_mfma_f32_32x32x16_bf16 v[48:63], v[20:23], v[12:15], v[48:63]
    s_add_u32 s37, s37, 2048
    s_sub_u32 s38, s38, 1
    s_nop 7
    s_nop 3
    v_max3_f32 v4, v48, v49, v4
    v_max3_f32 v4, v50, v51, v4
    v_max3_f32 v4, v52, v53, v4
    v_max3_f32 v4, v54, v55, v4
    v_max3_f32 v4, v56, v57, v4
    v_max3_f32 v4, v58, v59, v4
    v_max3_f32 v4, v60, v61, v4
    v_max3_f32 v4, v62, v63, v4
    s_cmp_lg_u32 s38, 0
    s_cbranch_scc1 KMA_MAXL
    v_mov_b32 v5, v4
    s_nop 1
    v_permlane32_swap_b32 v4, v5
    v_max_f32 v4, v4, v5
    v_cvt_pk_bf16_f32 v4, -v4, 0
    v_cndmask_b32 v14, v14, v4, s[60:61]
    v_mov_b32 v88, 0
    v_mov_b32 v89, 0
    v_mov_b32 v90, 0
    v_mov_b32 v91, 0
    v_mov_b32 v92, 0
    v_mov_b32 v93, 0
    v_mov_b32 v94, 0
    v_mov_b32 v95, 0
    v_mov_b32 v96, 0
    v_mov_b32 v97, 0
    v_mov_b32 v98, 0
    v_mov_b32 v99, 0
    v_mov_b32 v100, 0
    v_mov_b32 v101, 0
    v_mov_b32 v102, 0
    v_mov_b32 v103, 0
    v_mov_b32 v84, 0
    v_mov_b32 v44, 0
    v_mov_b32 v85, 0
    v_mov_b32 v45, 0
    v_mov_b32 v86, 0
    v_mov_b32 v46, 0
    v_mov_b32 v87, 0
    v_mov_b32 v47, 0
    s_waitcnt vmcnt(4)
    s_barrier
    ds_read_b128 v[16:19], v3
    ds_read_b128 v[20:23], v3 offset:1024
    ds_read_b128 v[24:27], v3 offset:2048
    ds_read_b128 v[28:31], v3 offset:3072
    ds_read_b128 v[32:35], v3 offset:4096
    ds_read_b128 v[36:39], v3 offset:5120
    s_waitcnt lgkmcnt(4)
    v_mfma_f32_32x32x16_bf16 v[48:63], v[16:19], v[8:11], 0
    v_mfma_f32_32x32x16_bf16 v[48:63], v[20:23], v[12:15], v[48:63]
    s_mov_b32 s39, 0
    s_mov_b32 s31, 0
KMA_LOOP:
    s_add_u32 s32, s31, 16384
    s_cmp_ge_u32 s32, 81920
    s_cselect_b32 s32, 0, s32
    s_add_u32 s48, s32, 16384
    s_cmp_ge_u32 s48, 81920
    s_cselect_b32 s48, 0, s48
    v_add_u32 v5, s31, v3
    v_add_u32 v6, s32, v3
    v_add_u32 v7, s48, v3
    s_waitcnt vmcnt(0)
    s_barrier
    s_cmp_ge_u32 s39, 7
    s_cbranch_scc1 KMA_NODMA
    s_add_u32 m0, s33, s29
    s_add_u32 s33, s33, 16384
    buffer_load_dwordx4 v2, s[20:23], s34 offen lds
    buffer_load_dwordx4 v2, s[20:23], s34 offen offset:1024 lds
    s_add_u32 s34, s34, 4096
    s_cmp_ge_u32 s33, 81920
    s_cselect_b32 s33, 0, s33
    s_cmp_ge_u32 s39, 6
    s_cbranch_scc1 KMA_NODMA
    s_add_u32 m0, s33, s29
    s_add_u32 s33, s33, 16384
    buffer_load_dwordx4 v2, s[20:23], s34 offen lds
    buffer_load_dwordx4 v2, s[20:23], s34 offen offset:1024 lds
    s_add_u32 s34, s34, 4096
    s_cmp_ge_u32 s33, 81920
    s_cselect_b32 s33, 0, s33
KMA_NODMA:
    ds_read_b128 v[16:19], v6 offset:0
    ds_read_b128 v[20:23], v6 offset:1024
    s_waitcnt lgkmcnt(4)
    v_mfma_f32_32x32x16_bf16 v[64:79], v[24:27], v[8:11], 0
    v_exp_f32 v48, v48
    v_exp_f32 v49, v49
    v_exp_f32 v50, v50
    v_exp_f32 v51, v51
    v_mfma_f32_32x32x16_bf16 v[88:103], v[44:47], v[84:87], v[88:103]
    ds_read_b128 v[40:43], v5 offset:6144
    ds_read_b128 v[44:47], v5 offset:7168
    v_exp_f32 v52, v52
    v_exp_f32 v53, v53
    v_exp_f32 v54, v54
    v_exp_f32 v55, v55
    v_mfma_f32_32x32x16_bf16 v[64:79], v[28:31], v[12:15], v[64:79]
    v_cvt_pk_bf16_f32 v80, v48, v49
    v_cvt_pk_bf16_f32 v81, v50, v51
    v_cvt_pk_bf16_f32 v82, v52, v53
    v_cvt_pk_bf16_f32 v83, v54, v55
    v_exp_f32 v56, v56
    v_exp_f32 v57, v57
    s_waitcnt lgkmcnt(4)
    v_mfma_f32_32x32x16_bf16 v[88:103], v[32:35], v[80:83], v[88:103]
    v_exp_f32 v58, v58
    v_exp_f32 v59, v59
    v_exp_f32 v60, v60
    v_exp_f32 v61, v61
    v_exp_f32 v62, v62
    v_exp_f32 v63, v63
    v_cvt_pk_bf16_f32 v84, v56, v57
    v_cvt_pk_bf16_f32 v85, v58, v59
    v_cvt_pk_bf16_f32 v86, v60, v61
    v_cvt_pk_bf16_f32 v87, v62, v63
    ds_read_b128 v[24:27], v6 offset:2048
    ds_read_b128 v[28:31], v6 offset:3072
    s_waitcnt lgkmcnt(4)
    v_mfma_f32_32x32x16_bf16 v[48:63], v[16:19], v[8:11], 0
    v_exp_f32 v64, v64
    v_exp_f32 v65, v65
    v_exp_f32 v66, v66
    v_exp_f32 v67, v67
    v_mfma_f32_32x32x16_bf16 v[88:103], v[36:39], v[84:87], v[88:103]
    ds_read_b128 v[32:35], v6 offset:4096
    ds_read_b128 v[36:39], v6 offset:5120
    v_exp_f32 v68, v68
    v_exp_f32 v69, v69
    v_exp_f32 v70, v70
    v_exp_f32 v71, v71
    v_mfma_f32_32x32x16_bf16 v[48:63], v[20:23], v[12:15], v[48:63]
    v_cvt_pk_bf16_f32 v80, v64, v65
    v_cvt_pk_bf16_f32 v81, v66, v67
    v_cvt_pk_bf16_f32 v82, v68, v69
    v_cvt_pk_bf16_f32 v83, v70, v71
    v_exp_f32 v72, v72
    v_exp_f32 v73, v73
    s_waitcnt lgkmcnt(4)
    v_mfma_f32_32x32x16_bf16 v[88:103], v[40:43], v[80:83], v[88:103]
    v_exp_f32 v74, v74
    v_exp_f32 v75, v75
    v_exp_f32 v76, v76
    v_exp_f32 v77, v77
    v_exp_f32 v78, v78
    v_exp_f32 v79, v79
    v_cvt_pk_bf16_f32 v84, v72, v73
    v_cvt_pk_bf16_f32 v85, v74, v75
    v_cvt_pk_bf16_f32 v86, v76, v77
    v_cvt_pk_bf16_f32 v87, v78, v79
    ds_read_b128 v[16:19], v7 offset:0
    ds_read_b128 v[20:23], v7 offset:1024
    s_waitcnt lgkmcnt(4)
    v_mfma_f32_32x32x16_bf16 v[64:79], v[24:27], v[8:11], 0
    v_exp_f32 v48, v48
    v_exp_f32 v49, v49
    v_exp_f32 v50, v50
    v_exp_f32 v51, v51
    v_mfma_f32_32x32x16_bf16 v[88:103], v[44:47], v[84:87], v[88:103]
    ds_read_b128 v[40:43], v6 offset:6144
    ds_read_b128 v[44:47], v6 offset:7168
    v_exp_f32 v52, v52
    v_exp_f32 v53, v53
    v_exp_f32 v54, v54
    v_exp_f32 v55, v55
    v_mfma_f32_32x32x16_bf16 v[64:79], v[28:31], v[12:15], v[64:79]
    v_cvt_pk_bf16_f32 v80, v48, v49
    v_cvt_pk_bf16_f32 v81, v50, v51
    v_cvt_pk_bf16_f32 v82, v52, v53
    v_cvt_pk_bf16_f32 v83, v54, v55
    v_exp_f32 v56, v56
    v_exp_f32 v57, v57
    s_waitcnt lgkmcnt(4)
    v_mfma_f32_32x32x16_bf16 v[88:103], v[32:35], v[80:83], v[88:103]
    v_exp_f32 v58, v58
    v_exp_f32 v59, v59
    v_exp_f32 v60, v60
    v_exp_f32 v61, v61
    v_exp_f32 v62, v62
    v_exp_f32 v63, v63
    v_cvt_pk_bf16_f32 v84, v56, v57
    v_cvt_pk_bf16_f32 v85, v58, v59
    v_cvt_pk_bf16_f32 v86, v60, v61
    v_cvt_pk_bf16_f32 v87, v62, v63
    ds_read_b128 v[24:27], v7 offset:2048
    ds_read_b128 v[28:31], v7 offset:3072
    s_waitcnt lgkmcnt(4)
    v_mfma_f32_32x32x16_bf16 v[48:63], v[16:19], v[8:11], 0
    v_exp_f32 v64, v64
    v_exp_f32 v65, v65
    v_exp_f32 v66, v66
    v_exp_f32 v67, v67
    v_mfma_f32_32x32x16_bf16 v[88:103], v[36:39], v[84:87], v[88:103]
    ds_read_b128 v[32:35], v7 offset:4096
    ds_read_b128 v[36:39], v7 offset:5120
    v_exp_f32 v68, v68
    v_exp_f32 v69, v69
    v_exp_f32 v70, v70
    v_exp_f32 v71, v71
    v_mfma_f32_32x32x16_bf16 v[48:63], v[20:23], v[12:15], v[48:63]
    v_cvt_pk_bf16_f32 v80, v64, v65
    v_cvt_pk_bf16_f32 v81, v66, v67
    v_cvt_pk_bf16_f32 v82, v68, v69
    v_cvt_pk_bf16_f32 v83, v70, v71
    v_exp_f32 v72, v72
    v_exp_f32 v73, v73
    s_waitcnt lgkmcnt(4)
    v_mfma_f32_32x32x16_bf16 v[88:103], v[40:43], v[80:83], v[88:103]
    v_exp_f32 v74, v74
    v_exp_f32 v75, v75
    v_exp_f32 v76, v76
    v_exp_f32 v77, v77
    v_exp_f32 v78, v78
    v_exp_f32 v79, v79
    v_cvt_pk_bf16_f32 v84, v72, v73
    v_cvt_pk_bf16_f32 v85, v74, v75
    v_cvt_pk_bf16_f32 v86, v76, v77
    v_cvt_pk_bf16_f32 v87, v78, v79
    s_mov_b32 s31, s48
    s_add_u32 s39, s39, 1
    s_cmp_lt_u32 s39, 8
    s_cbranch_scc1 KMA_LOOP
    v_mfma_f32_32x32x16_bf16 v[88:103], v[44:47], v[84:87], v[88:103]
    s_lshl_b32 s35, s46, 12
    v_add_u32 v6, s35, v2
    v_and_b32 v4, 31, v1
    v_lshlrev_b32 v4, 2, v4
    s_lshl_b32 s35, s27, 7
    s_add_u32 s35, s35, 29360128
    buffer_load_dword v7, v4, s[20:23], s35 offen
    s_waitcnt lgkmcnt(0)
    s_barrier
    s_nop 7
    s_cmp_eq_u32 s47, 0
    s_cbranch_scc1 KMA_M1
    ds_write_b128 v6, v[88:91] offset:0
    ds_write_b128 v6, v[92:95] offset:1024
    ds_write_b128 v6, v[96:99] offset:2048
    ds_write_b128 v6, v[100:103] offset:3072
KMA_M1:
    s_waitcnt lgkmcnt(0)
    s_barrier
    s_mov_b32 s35, 0
    s_cmp_lg_u32 s47, 0
    s_cbranch_scc1 KMA_M2
    ds_read_b128 v[48:51], v6 offset:0
    ds_read_b128 v[52:55], v6 offset:1024
    ds_read_b128 v[56:59], v6 offset:2048
    ds_read_b128 v[60:63], v6 offset:3072
    s_waitcnt lgkmcnt(0)
    v_add_f32 v88, v88, v48
    v_add_f32 v89, v89, v49
    v_add_f32 v90, v90, v50
    v_add_f32 v91, v91, v51
    v_add_f32 v92, v92, v52
    v_add_f32 v93, v93, v53
    v_add_f32 v94, v94, v54
    v_add_f32 v95, v95, v55
    v_add_f32 v96, v96, v56
    v_add_f32 v97, v97, v57
    v_add_f32 v98, v98, v58
    v_add_f32 v99, v99, v59
    v_add_f32 v100, v100, v60
    v_add_f32 v101, v101, v61
    v_add_f32 v102, v102, v62
    v_add_f32 v103, v103, v63
    v_mov_b32 v4, v100
    v_mov_b32 v5, v100
    s_nop 1
    v_permlane32_swap_b32 v4, v5
    v_cmp_nge_f32 vcc, 0x71800000, v5
    s_cmp_lg_u64 vcc, 0
    s_cselect_b32 s35, 1, 0
KMA_M2:
    s_cmp_lg_u32 s45, 0
    s_cbranch_scc1 KMA_FIN
    v_mov_b32 v4, s35
    v_mov_b32 v16, s26
    v_lshlrev_b32 v16, 2, v16
    ds_write_b32 v16, v4 offset:32768
    s_waitcnt lgkmcnt(0)
    s_barrier
    v_mov_b32 v16, 0
    ds_read_b128 v[20:23], v16 offset:32768
    s_waitcnt lgkmcnt(0)
    v_or3_b32 v17, v20, v21, v22
    v_or_b32 v17, v17, v23
    s_nop 0
    v_readfirstlane_b32 s35, v17
    s_cmp_eq_u32 s35, 0
    s_cbranch_scc1 KMA_FIN
    s_barrier
    s_mov_b32 s44, 64
    s_mov_b32 s45, 1
    s_branch KMA_START
KMA_FIN:
    s_cmp_lg_u32 s47, 0
    s_cbranch_scc1 KM_END2
    v_rcp_f32 v5, v5
    s_lshl_b32 s35, s27, 15
    s_lshl_b32 s36, s24, 11
    s_add_u32 s35, s35, s36
    s_add_u32 s35, s35, 20971520
    s_waitcnt vmcnt(0)
    v_mul_f32 v5, v5, v7
    v_mul_f32 v88, v5, v88
    v_mul_f32 v89, v5, v89
    v_mul_f32 v90, v5, v90
    v_mul_f32 v91, v5, v91
    v_mul_f32 v92, v5, v92
    v_mul_f32 v93, v5, v93
    v_mul_f32 v94, v5, v94
    v_mul_f32 v95, v5, v95
    v_mul_f32 v96, v5, v96
    v_mul_f32 v97, v5, v97
    v_mul_f32 v98, v5, v98
    v_mul_f32 v99, v5, v99
    v_mul_f32 v100, v5, v100
    v_mul_f32 v101, v5, v101
    v_mul_f32 v102, v5, v102
    v_mul_f32 v103, v5, v103
    v_cvt_pk_bf16_f32 v80, v88, v89
    v_cvt_pk_bf16_f32 v81, v90, v91
    v_cvt_pk_bf16_f32 v82, v92, v93
    v_cvt_pk_bf16_f32 v83, v94, v95
    v_cvt_pk_bf16_f32 v84, v96, v97
    v_cvt_pk_bf16_f32 v85, v98, v99
    v_cvt_pk_bf16_f32 v86, v100, v101
    v_cvt_pk_bf16_f32 v87, v102, v103
    buffer_store_dwordx4 v[80:83], v2, s[20:23], s35 offen sc1
    buffer_store_dwordx4 v[84:87], v2, s[20:23], s35 offen offset:1024 sc1
    s_add_u32 s29, s25, 32
    s_waitcnt vmcnt(0)
    s_barrier
    s_cmp_lg_u32 s26, 0
    s_cbranch_scc1 KMA_S
    s_lshl_b32 s35, s29, 8
    s_add_u32 s35, s35, 32505856
    v_mov_b32 v3, 0
    v_mov_b32 v4, 1
    s_mov_b64 s[36:37], exec
    s_mov_b64 exec, 1
    buffer_atomic_add v4, v3, s[20:23], s35 offen sc1
    s_mov_b64 exec, s[36:37]
KMA_S:
KM_END2:
KM_END:
    s_endpgm
.section .rodata,"a"
.p2align 6
.amdhsa_kernel km_kernel
  .amdhsa_next_free_vgpr 128
  .amdhsa_next_free_sgpr 102
  .amdhsa_accum_offset 128
  .amdhsa_group_segment_fixed_size 0
  .amdhsa_kernarg_size 96
  .amdhsa_user_sgpr_count 2
  .amdhsa_user_sgpr_kernarg_segment_ptr 1
  .amdhsa_system_sgpr_workgroup_id_x 1
.end_amdhsa_kernel
```
